```python
import torch

def _softmax(x, axis=-1):
    return torch.softmax(x, dim=axis)
def _gelu(x):
    return torch.nn.functional.gelu(x, approximate="tanh")
def _silu(x):
    return torch.nn.functional.silu(x)
def _sigmoid(x):
    return torch.sigmoid(x)
def _layernorm(x, axis=-1, eps=1e-5):
    m = x.mean(dim=axis, keepdim=True)
    v = x.var(dim=axis, keepdim=True, unbiased=False)
    return (x - m) / torch.sqrt(v + eps)
def _scatter_add(tgt, idx, src, axis=0):
    return tgt.clone().index_add_(axis, idx, src)
def _segment_sum(src, seg, n):
    out = torch.zeros((n,) + src.shape[1:], dtype=src.dtype)
    return out.index_add_(0, seg, src)
def _pad(x, pw):
    flat = tuple(v for pair in reversed(pw) for v in pair)
    return torch.nn.functional.pad(x, flat)

kernel_name = 'standalone__channel_attn_se__vision'

def setup_inputs():

    _w = (lambda a: (lambda t: t.to(torch.bfloat16) if t.is_floating_point() else t)(torch.as_tensor(a)))
    H = W = 256
    C = 384
    r = max(C // 16, 4)
    return {
        "x": _w((lambda *s: torch.randn(*s, dtype=torch.bfloat16) * 1.6)(1, H, W, C)),
        "w_down": _w((lambda *s: torch.randn(*s, dtype=torch.bfloat16) * 3.2)(C, r)),
        "w_up": _w((lambda *s: torch.randn(*s, dtype=torch.bfloat16) * 1.6)(r, C)),
    }

def reference(x, w_down, w_up):
    s = x.mean(axis=(1, 2))
    h = _silu(torch.einsum('bc,cr->br', s, w_down))
    g = _sigmoid(torch.einsum('br,rc->bc', h, w_up))
    return x * g[:, None, None, :]
```

```asm
; @launch grid=(256,1,1) block=(768,1,1) lds=27776
.amdgcn_target "amdgcn-amd-amdhsa--gfx950"
.text
.globl standalone__channel_attn_se__vision_kernel
.p2align 8
.type standalone__channel_attn_se__vision_kernel,@function
standalone__channel_attn_se__vision_kernel:
    s_cmp_ge_u32 s2, 256
    s_cbranch_scc1 L_end
    s_load_dwordx4 s[36:39], s[0:1], 0
    s_load_dwordx4 s[40:43], s[0:1], 16
    s_load_dwordx4 s[44:47], s[0:1], 32
    v_lshlrev_b32 v1, 4, v0
    s_mul_i32 s28, s2, 196608
    s_add_u32 s48, s28, 0
    s_add_u32 s49, s28, 12288
    s_add_u32 s50, s28, 24576
    s_add_u32 s51, s28, 36864
    s_add_u32 s52, s28, 49152
    s_add_u32 s53, s28, 61440
    s_add_u32 s54, s28, 73728
    s_add_u32 s55, s28, 86016
    s_add_u32 s56, s28, 98304
    s_add_u32 s57, s28, 110592
    s_add_u32 s58, s28, 122880
    s_add_u32 s59, s28, 135168
    s_add_u32 s60, s28, 147456
    s_add_u32 s61, s28, 159744
    s_add_u32 s62, s28, 172032
    s_add_u32 s63, s28, 184320
    s_mov_b32 s64, 0
    s_mov_b32 s65, 3072
    s_mov_b32 s66, 6144
    s_mov_b32 s67, 9216
    s_mov_b32 s68, 12288
    s_mov_b32 s69, 15360
    s_mov_b32 s70, 18432
    s_mov_b32 s71, 21504
    s_waitcnt lgkmcnt(0)
    s_mov_b32 s4, s36
    s_mov_b32 s5, s37
    s_mov_b32 s6, 50331648
    s_mov_b32 s7, 0x00020000
    s_mov_b32 s8, s42
    s_mov_b32 s9, s43
    s_mov_b32 s10, 50331648
    s_mov_b32 s11, 0x00020000
    s_mov_b32 s12, s46
    s_mov_b32 s13, s47
    s_mov_b32 s14, 36864
    s_mov_b32 s15, 0x00020000
    s_mov_b32 s16, s44
    s_mov_b32 s17, s45
    s_mov_b32 s18, 256
    s_mov_b32 s19, 0x00020000
    s_mov_b32 s20, s38
    s_mov_b32 s21, s39
    s_mov_b32 s22, 18432
    s_mov_b32 s23, 0x00020000
    s_mov_b32 s24, s40
    s_mov_b32 s25, s41
    s_mov_b32 s26, 18432
    s_mov_b32 s27, 0x00020000
    s_cmp_lg_u32 s2, 0
    s_cbranch_scc1 L_nozero
    v_mov_b32 v6, 0
    v_mov_b32 v7, 0
    v_mov_b32 v8, 0
    v_mov_b32 v9, 0
    s_mov_b32 s29, 12288
    s_mov_b32 s30, 24576
    buffer_store_dwordx4 v[6:9], v1, s[12:15], 0 offen sc1
    buffer_store_dwordx4 v[6:9], v1, s[12:15], s29 offen sc1
    buffer_store_dwordx4 v[6:9], v1, s[12:15], s30 offen sc1
L_nozero:
    buffer_load_dwordx4 v[32:35], v1, s[4:7], s48 offen
    buffer_load_dwordx4 v[36:39], v1, s[4:7], s49 offen
    buffer_load_dwordx4 v[40:43], v1, s[4:7], s50 offen
    buffer_load_dwordx4 v[44:47], v1, s[4:7], s51 offen
    buffer_load_dwordx4 v[48:51], v1, s[4:7], s52 offen
    buffer_load_dwordx4 v[52:55], v1, s[4:7], s53 offen
    buffer_load_dwordx4 v[56:59], v1, s[4:7], s54 offen
    buffer_load_dwordx4 v[60:63], v1, s[4:7], s55 offen
    buffer_load_dwordx4 v[64:67], v1, s[4:7], s56 offen
    buffer_load_dwordx4 v[68:71], v1, s[4:7], s57 offen
    buffer_load_dwordx4 v[72:75], v1, s[4:7], s58 offen
    buffer_load_dwordx4 v[76:79], v1, s[4:7], s59 offen
    buffer_load_dwordx4 v[80:83], v1, s[4:7], s60 offen
    buffer_load_dwordx4 v[84:87], v1, s[4:7], s61 offen
    buffer_load_dwordx4 v[88:91], v1, s[4:7], s62 offen
    buffer_load_dwordx4 v[92:95], v1, s[4:7], s63 offen
    v_mul_u32_u24 v2, 0x556, v0
    v_lshrrev_b32 v2, 16, v2
    v_mul_u32_u24 v3, 48, v2
    v_sub_u32 v3, v0, v3
    v_lshrrev_b32 v6, 6, v0
    s_nop 0
    v_readfirstlane_b32 s31, v6
    v_and_b32 v6, 63, v0
    v_mul_u32_u24 v4, 48, v6
    s_lshl_b32 s32, s31, 2
    v_add_u32 v4, s32, v4
    v_lshlrev_b32 v5, 1, v0
    buffer_load_dword v96, v4, s[20:23], s64 offen
    buffer_load_dword v97, v4, s[20:23], s65 offen
    buffer_load_dword v98, v4, s[20:23], s66 offen
    buffer_load_dword v99, v4, s[20:23], s67 offen
    buffer_load_dword v100, v4, s[20:23], s68 offen
    buffer_load_dword v101, v4, s[20:23], s69 offen
    buffer_load_ushort v108, v5, s[24:27], s64 offen offset:0
    buffer_load_ushort v109, v5, s[24:27], s64 offen offset:768
    buffer_load_ushort v110, v5, s[24:27], s64 offen offset:1536
    buffer_load_ushort v111, v5, s[24:27], s64 offen offset:2304
    buffer_load_ushort v112, v5, s[24:27], s65 offen offset:0
    buffer_load_ushort v113, v5, s[24:27], s65 offen offset:768
    buffer_load_ushort v114, v5, s[24:27], s65 offen offset:1536
    buffer_load_ushort v115, v5, s[24:27], s65 offen offset:2304
    buffer_load_ushort v116, v5, s[24:27], s66 offen offset:0
    buffer_load_ushort v117, v5, s[24:27], s66 offen offset:768
    buffer_load_ushort v118, v5, s[24:27], s66 offen offset:1536
    buffer_load_ushort v119, v5, s[24:27], s66 offen offset:2304
    buffer_load_ushort v120, v5, s[24:27], s67 offen offset:0
    buffer_load_ushort v121, v5, s[24:27], s67 offen offset:768
    buffer_load_ushort v122, v5, s[24:27], s67 offen offset:1536
    buffer_load_ushort v123, v5, s[24:27], s67 offen offset:2304
    buffer_load_ushort v124, v5, s[24:27], s68 offen offset:0
    buffer_load_ushort v125, v5, s[24:27], s68 offen offset:768
    buffer_load_ushort v126, v5, s[24:27], s68 offen offset:1536
    buffer_load_ushort v127, v5, s[24:27], s68 offen offset:2304
    buffer_load_ushort v128, v5, s[24:27], s69 offen offset:0
    buffer_load_ushort v129, v5, s[24:27], s69 offen offset:768
    buffer_load_ushort v130, v5, s[24:27], s69 offen offset:1536
    buffer_load_ushort v131, v5, s[24:27], s69 offen offset:2304
    s_cmp_lg_u32 s2, 0
    s_cbranch_scc1 L_nozflag
    s_waitcnt vmcnt(46)
    s_barrier
    s_cmp_lg_u32 s31, 0
    s_cbranch_scc1 L_nozflag
    v_mov_b32 v6, 1
    v_mov_b32 v7, 0
    v_cmp_eq_u32 vcc, 0, v0
    s_and_saveexec_b64 s[34:35], vcc
    buffer_store_dword v6, v7, s[16:19], 0 offen sc1
    s_mov_b64 exec, s[34:35]
L_nozflag:
    v_mov_b32 v16, 0
    v_mov_b32 v17, 0
    v_mov_b32 v18, 0
    v_mov_b32 v19, 0
    v_mov_b32 v20, 0
    v_mov_b32 v21, 0
    v_mov_b32 v22, 0
    v_mov_b32 v23, 0
    s_waitcnt vmcnt(45)
    v_lshlrev_b32 v6, 16, v32
    v_and_b32 v7, 0xffff0000, v32
    v_pk_add_f32 v[16:17], v[16:17], v[6:7]
    v_lshlrev_b32 v8, 16, v33
    v_and_b32 v9, 0xffff0000, v33
    v_pk_add_f32 v[18:19], v[18:19], v[8:9]
    v_lshlrev_b32 v6, 16, v34
    v_and_b32 v7, 0xffff0000, v34
    v_pk_add_f32 v[20:21], v[20:21], v[6:7]
    v_lshlrev_b32 v8, 16, v35
    v_and_b32 v9, 0xffff0000, v35
    v_pk_add_f32 v[22:23], v[22:23], v[8:9]
    s_waitcnt vmcnt(44)
    v_lshlrev_b32 v6, 16, v36
    v_and_b32 v7, 0xffff0000, v36
    v_pk_add_f32 v[16:17], v[16:17], v[6:7]
    v_lshlrev_b32 v8, 16, v37
    v_and_b32 v9, 0xffff0000, v37
    v_pk_add_f32 v[18:19], v[18:19], v[8:9]
    v_lshlrev_b32 v6, 16, v38
    v_and_b32 v7, 0xffff0000, v38
    v_pk_add_f32 v[20:21], v[20:21], v[6:7]
    v_lshlrev_b32 v8, 16, v39
    v_and_b32 v9, 0xffff0000, v39
    v_pk_add_f32 v[22:23], v[22:23], v[8:9]
    s_waitcnt vmcnt(43)
    v_lshlrev_b32 v6, 16, v40
    v_and_b32 v7, 0xffff0000, v40
    v_pk_add_f32 v[16:17], v[16:17], v[6:7]
    v_lshlrev_b32 v8, 16, v41
    v_and_b32 v9, 0xffff0000, v41
    v_pk_add_f32 v[18:19], v[18:19], v[8:9]
    v_lshlrev_b32 v6, 16, v42
    v_and_b32 v7, 0xffff0000, v42
    v_pk_add_f32 v[20:21], v[20:21], v[6:7]
    v_lshlrev_b32 v8, 16, v43
    v_and_b32 v9, 0xffff0000, v43
    v_pk_add_f32 v[22:23], v[22:23], v[8:9]
    s_waitcnt vmcnt(42)
    v_lshlrev_b32 v6, 16, v44
    v_and_b32 v7, 0xffff0000, v44
    v_pk_add_f32 v[16:17], v[16:17], v[6:7]
    v_lshlrev_b32 v8, 16, v45
    v_and_b32 v9, 0xffff0000, v45
    v_pk_add_f32 v[18:19], v[18:19], v[8:9]
    v_lshlrev_b32 v6, 16, v46
    v_and_b32 v7, 0xffff0000, v46
    v_pk_add_f32 v[20:21], v[20:21], v[6:7]
    v_lshlrev_b32 v8, 16, v47
    v_and_b32 v9, 0xffff0000, v47
    v_pk_add_f32 v[22:23], v[22:23], v[8:9]
    s_waitcnt vmcnt(41)
    v_lshlrev_b32 v6, 16, v48
    v_and_b32 v7, 0xffff0000, v48
    v_pk_add_f32 v[16:17], v[16:17], v[6:7]
    v_lshlrev_b32 v8, 16, v49
    v_and_b32 v9, 0xffff0000, v49
    v_pk_add_f32 v[18:19], v[18:19], v[8:9]
    v_lshlrev_b32 v6, 16, v50
    v_and_b32 v7, 0xffff0000, v50
    v_pk_add_f32 v[20:21], v[20:21], v[6:7]
    v_lshlrev_b32 v8, 16, v51
    v_and_b32 v9, 0xffff0000, v51
    v_pk_add_f32 v[22:23], v[22:23], v[8:9]
    s_waitcnt vmcnt(40)
    v_lshlrev_b32 v6, 16, v52
    v_and_b32 v7, 0xffff0000, v52
    v_pk_add_f32 v[16:17], v[16:17], v[6:7]
    v_lshlrev_b32 v8, 16, v53
    v_and_b32 v9, 0xffff0000, v53
    v_pk_add_f32 v[18:19], v[18:19], v[8:9]
    v_lshlrev_b32 v6, 16, v54
    v_and_b32 v7, 0xffff0000, v54
    v_pk_add_f32 v[20:21], v[20:21], v[6:7]
    v_lshlrev_b32 v8, 16, v55
    v_and_b32 v9, 0xffff0000, v55
    v_pk_add_f32 v[22:23], v[22:23], v[8:9]
    s_waitcnt vmcnt(39)
    v_lshlrev_b32 v6, 16, v56
    v_and_b32 v7, 0xffff0000, v56
    v_pk_add_f32 v[16:17], v[16:17], v[6:7]
    v_lshlrev_b32 v8, 16, v57
    v_and_b32 v9, 0xffff0000, v57
    v_pk_add_f32 v[18:19], v[18:19], v[8:9]
    v_lshlrev_b32 v6, 16, v58
    v_and_b32 v7, 0xffff0000, v58
    v_pk_add_f32 v[20:21], v[20:21], v[6:7]
    v_lshlrev_b32 v8, 16, v59
    v_and_b32 v9, 0xffff0000, v59
    v_pk_add_f32 v[22:23], v[22:23], v[8:9]
    s_waitcnt vmcnt(38)
    v_lshlrev_b32 v6, 16, v60
    v_and_b32 v7, 0xffff0000, v60
    v_pk_add_f32 v[16:17], v[16:17], v[6:7]
    v_lshlrev_b32 v8, 16, v61
    v_and_b32 v9, 0xffff0000, v61
    v_pk_add_f32 v[18:19], v[18:19], v[8:9]
    v_lshlrev_b32 v6, 16, v62
    v_and_b32 v7, 0xffff0000, v62
    v_pk_add_f32 v[20:21], v[20:21], v[6:7]
    v_lshlrev_b32 v8, 16, v63
    v_and_b32 v9, 0xffff0000, v63
    v_pk_add_f32 v[22:23], v[22:23], v[8:9]
    s_waitcnt vmcnt(37)
    v_lshlrev_b32 v6, 16, v64
    v_and_b32 v7, 0xffff0000, v64
    v_pk_add_f32 v[16:17], v[16:17], v[6:7]
    v_lshlrev_b32 v8, 16, v65
    v_and_b32 v9, 0xffff0000, v65
    v_pk_add_f32 v[18:19], v[18:19], v[8:9]
    v_lshlrev_b32 v6, 16, v66
    v_and_b32 v7, 0xffff0000, v66
    v_pk_add_f32 v[20:21], v[20:21], v[6:7]
    v_lshlrev_b32 v8, 16, v67
    v_and_b32 v9, 0xffff0000, v67
    v_pk_add_f32 v[22:23], v[22:23], v[8:9]
    s_waitcnt vmcnt(36)
    v_lshlrev_b32 v6, 16, v68
    v_and_b32 v7, 0xffff0000, v68
    v_pk_add_f32 v[16:17], v[16:17], v[6:7]
    v_lshlrev_b32 v8, 16, v69
    v_and_b32 v9, 0xffff0000, v69
    v_pk_add_f32 v[18:19], v[18:19], v[8:9]
    v_lshlrev_b32 v6, 16, v70
    v_and_b32 v7, 0xffff0000, v70
    v_pk_add_f32 v[20:21], v[20:21], v[6:7]
    v_lshlrev_b32 v8, 16, v71
    v_and_b32 v9, 0xffff0000, v71
    v_pk_add_f32 v[22:23], v[22:23], v[8:9]
    v_mov_b32 v10, 0
    buffer_load_dword v132, v10, s[16:19], 0 offen sc1
    s_waitcnt vmcnt(36)
    v_lshlrev_b32 v6, 16, v72
    v_and_b32 v7, 0xffff0000, v72
    v_pk_add_f32 v[16:17], v[16:17], v[6:7]
    v_lshlrev_b32 v8, 16, v73
    v_and_b32 v9, 0xffff0000, v73
    v_pk_add_f32 v[18:19], v[18:19], v[8:9]
    v_lshlrev_b32 v6, 16, v74
    v_and_b32 v7, 0xffff0000, v74
    v_pk_add_f32 v[20:21], v[20:21], v[6:7]
    v_lshlrev_b32 v8, 16, v75
    v_and_b32 v9, 0xffff0000, v75
    v_pk_add_f32 v[22:23], v[22:23], v[8:9]
    s_waitcnt vmcnt(35)
    v_lshlrev_b32 v6, 16, v76
    v_and_b32 v7, 0xffff0000, v76
    v_pk_add_f32 v[16:17], v[16:17], v[6:7]
    v_lshlrev_b32 v8, 16, v77
    v_and_b32 v9, 0xffff0000, v77
    v_pk_add_f32 v[18:19], v[18:19], v[8:9]
    v_lshlrev_b32 v6, 16, v78
    v_and_b32 v7, 0xffff0000, v78
    v_pk_add_f32 v[20:21], v[20:21], v[6:7]
    v_lshlrev_b32 v8, 16, v79
    v_and_b32 v9, 0xffff0000, v79
    v_pk_add_f32 v[22:23], v[22:23], v[8:9]
    s_waitcnt vmcnt(34)
    v_lshlrev_b32 v6, 16, v80
    v_and_b32 v7, 0xffff0000, v80
    v_pk_add_f32 v[16:17], v[16:17], v[6:7]
    v_lshlrev_b32 v8, 16, v81
    v_and_b32 v9, 0xffff0000, v81
    v_pk_add_f32 v[18:19], v[18:19], v[8:9]
    v_lshlrev_b32 v6, 16, v82
    v_and_b32 v7, 0xffff0000, v82
    v_pk_add_f32 v[20:21], v[20:21], v[6:7]
    v_lshlrev_b32 v8, 16, v83
    v_and_b32 v9, 0xffff0000, v83
    v_pk_add_f32 v[22:23], v[22:23], v[8:9]
    s_waitcnt vmcnt(33)
    v_lshlrev_b32 v6, 16, v84
    v_and_b32 v7, 0xffff0000, v84
    v_pk_add_f32 v[16:17], v[16:17], v[6:7]
    v_lshlrev_b32 v8, 16, v85
    v_and_b32 v9, 0xffff0000, v85
    v_pk_add_f32 v[18:19], v[18:19], v[8:9]
    v_lshlrev_b32 v6, 16, v86
    v_and_b32 v7, 0xffff0000, v86
    v_pk_add_f32 v[20:21], v[20:21], v[6:7]
    v_lshlrev_b32 v8, 16, v87
    v_and_b32 v9, 0xffff0000, v87
    v_pk_add_f32 v[22:23], v[22:23], v[8:9]
    s_waitcnt vmcnt(32)
    v_lshlrev_b32 v6, 16, v88
    v_and_b32 v7, 0xffff0000, v88
    v_pk_add_f32 v[16:17], v[16:17], v[6:7]
    v_lshlrev_b32 v8, 16, v89
    v_and_b32 v9, 0xffff0000, v89
    v_pk_add_f32 v[18:19], v[18:19], v[8:9]
    v_lshlrev_b32 v6, 16, v90
    v_and_b32 v7, 0xffff0000, v90
    v_pk_add_f32 v[20:21], v[20:21], v[6:7]
    v_lshlrev_b32 v8, 16, v91
    v_and_b32 v9, 0xffff0000, v91
    v_pk_add_f32 v[22:23], v[22:23], v[8:9]
    s_waitcnt vmcnt(31)
    v_lshlrev_b32 v6, 16, v92
    v_and_b32 v7, 0xffff0000, v92
    v_pk_add_f32 v[16:17], v[16:17], v[6:7]
    v_lshlrev_b32 v8, 16, v93
    v_and_b32 v9, 0xffff0000, v93
    v_pk_add_f32 v[18:19], v[18:19], v[8:9]
    v_lshlrev_b32 v6, 16, v94
    v_and_b32 v7, 0xffff0000, v94
    v_pk_add_f32 v[20:21], v[20:21], v[6:7]
    v_lshlrev_b32 v8, 16, v95
    v_and_b32 v9, 0xffff0000, v95
    v_pk_add_f32 v[22:23], v[22:23], v[8:9]
    v_lshlrev_b32 v6, 5, v0
    ds_write_b128 v6, v[16:19] offset:0
    ds_write_b128 v6, v[20:23] offset:16
    s_waitcnt vmcnt(25)
    v_and_b32 v107, 0xffff0000, v101
    v_lshlrev_b32 v106, 16, v101
    v_and_b32 v105, 0xffff0000, v100
    v_lshlrev_b32 v104, 16, v100
    v_and_b32 v103, 0xffff0000, v99
    v_lshlrev_b32 v102, 16, v99
    v_and_b32 v101, 0xffff0000, v98
    v_lshlrev_b32 v100, 16, v98
    v_and_b32 v99, 0xffff0000, v97
    v_lshlrev_b32 v98, 16, v97
    v_and_b32 v97, 0xffff0000, v96
    v_lshlrev_b32 v96, 16, v96
    s_waitcnt vmcnt(0)
    v_lshlrev_b32 v108, 16, v108
    v_lshlrev_b32 v109, 16, v109
    v_lshlrev_b32 v110, 16, v110
    v_lshlrev_b32 v111, 16, v111
    v_lshlrev_b32 v112, 16, v112
    v_lshlrev_b32 v113, 16, v113
    v_lshlrev_b32 v114, 16, v114
    v_lshlrev_b32 v115, 16, v115
    v_lshlrev_b32 v116, 16, v116
    v_lshlrev_b32 v117, 16, v117
    v_lshlrev_b32 v118, 16, v118
    v_lshlrev_b32 v119, 16, v119
    v_lshlrev_b32 v120, 16, v120
    v_lshlrev_b32 v121, 16, v121
    v_lshlrev_b32 v122, 16, v122
    v_lshlrev_b32 v123, 16, v123
    v_lshlrev_b32 v124, 16, v124
    v_lshlrev_b32 v125, 16, v125
    v_lshlrev_b32 v126, 16, v126
    v_lshlrev_b32 v127, 16, v127
    v_lshlrev_b32 v128, 16, v128
    v_lshlrev_b32 v129, 16, v129
    v_lshlrev_b32 v130, 16, v130
    v_lshlrev_b32 v131, 16, v131
    s_cmp_lg_u32 s31, 0
    s_cbranch_scc1 L_zok
    s_mov_b32 s33, 0
L_zpoll:
    v_cmp_ne_u32 vcc, 0, v132
    s_nop 4
    s_cbranch_vccnz L_zok
    s_add_u32 s33, s33, 1
    s_cmp_lt_u32 s33, 2000000
    s_cbranch_scc0 L_zok
    s_sleep 1
    v_mov_b32 v10, 0
    buffer_load_dword v132, v10, s[16:19], 0 offen sc1
    s_waitcnt vmcnt(0)
    s_branch L_zpoll
L_zok:
    s_waitcnt lgkmcnt(0)
    s_barrier
    s_cmp_ge_u32 s31, 6
    s_cbranch_scc1 L_b2
    v_lshlrev_b32 v6, 2, v0
    ds_read_b32 v16, v6 offset:0
    ds_read_b32 v17, v6 offset:1536
    ds_read_b32 v18, v6 offset:3072
    ds_read_b32 v19, v6 offset:4608
    ds_read_b32 v20, v6 offset:6144
    ds_read_b32 v21, v6 offset:7680
    ds_read_b32 v22, v6 offset:9216
    ds_read_b32 v23, v6 offset:10752
    ds_read_b32 v24, v6 offset:12288
    ds_read_b32 v25, v6 offset:13824
    ds_read_b32 v26, v6 offset:15360
    ds_read_b32 v27, v6 offset:16896
    ds_read_b32 v28, v6 offset:18432
    ds_read_b32 v29, v6 offset:19968
    ds_read_b32 v30, v6 offset:21504
    ds_read_b32 v31, v6 offset:23040
    s_and_b32 s33, s2, 15
    s_mul_i32 s33, s33, 1536
    v_add_u32 v7, s33, v6
    s_waitcnt lgkmcnt(0)
    v_add_f32 v16, v16, v24
    v_add_f32 v17, v17, v25
    v_add_f32 v18, v18, v26
    v_add_f32 v19, v19, v27
    v_add_f32 v20, v20, v28
    v_add_f32 v21, v21, v29
    v_add_f32 v22, v22, v30
    v_add_f32 v23, v23, v31
    v_add_f32 v16, v16, v20
    v_add_f32 v17, v17, v21
    v_add_f32 v18, v18, v22
    v_add_f32 v19, v19, v23
    v_add_f32 v16, v16, v18
    v_add_f32 v17, v17, v19
    v_add_f32 v16, v16, v17
    buffer_atomic_add_f32 v16, v7, s[12:15], 0 offen
    s_waitcnt vmcnt(0)
L_b2:
    s_barrier
    s_cmp_lg_u32 s31, 0
    s_cbranch_scc1 L_b3
    s_and_b32 s33, s2, 15
    s_lshl_b32 s33, s33, 8
    s_add_u32 s33, s33, 24576
    v_mov_b32 v6, s33
    v_mov_b32 v7, 1
    v_cmp_eq_u32 vcc, 0, v0
    s_and_saveexec_b64 s[34:35], vcc
    buffer_atomic_add v7, v6, s[12:15], 0 offen
    s_mov_b64 exec, s[34:35]
    v_and_b32 v8, 15, v0
    v_lshlrev_b32 v8, 8, v8
    v_add_u32 v8, 24576, v8
    s_mov_b32 s33, 0
L_poll:
    buffer_load_dword v9, v8, s[12:15], 0 offen sc1
    s_waitcnt vmcnt(0)
    v_cmp_ne_u32 vcc, 16, v9
    s_nop 4
    s_cbranch_vccz L_b3
    s_add_u32 s33, s33, 1
    s_cmp_lt_u32 s33, 2000000
    s_cbranch_scc0 L_b3
    s_sleep 1
    s_branch L_poll
L_b3:
    s_barrier
    s_cmp_ge_u32 s31, 6
    s_cbranch_scc1 L_b4
    v_lshlrev_b32 v6, 2, v0
    buffer_load_dword v16, v6, s[12:15], s64 offen offset:0 sc1
    buffer_load_dword v17, v6, s[12:15], s64 offen offset:1536 sc1
    buffer_load_dword v18, v6, s[12:15], s65 offen offset:0 sc1
    buffer_load_dword v19, v6, s[12:15], s65 offen offset:1536 sc1
    buffer_load_dword v20, v6, s[12:15], s66 offen offset:0 sc1
    buffer_load_dword v21, v6, s[12:15], s66 offen offset:1536 sc1
    buffer_load_dword v22, v6, s[12:15], s67 offen offset:0 sc1
    buffer_load_dword v23, v6, s[12:15], s67 offen offset:1536 sc1
    buffer_load_dword v24, v6, s[12:15], s68 offen offset:0 sc1
    buffer_load_dword v25, v6, s[12:15], s68 offen offset:1536 sc1
    buffer_load_dword v26, v6, s[12:15], s69 offen offset:0 sc1
    buffer_load_dword v27, v6, s[12:15], s69 offen offset:1536 sc1
    buffer_load_dword v28, v6, s[12:15], s70 offen offset:0 sc1
    buffer_load_dword v29, v6, s[12:15], s70 offen offset:1536 sc1
    buffer_load_dword v30, v6, s[12:15], s71 offen offset:0 sc1
    buffer_load_dword v31, v6, s[12:15], s71 offen offset:1536 sc1
    s_waitcnt vmcnt(0)
    v_add_f32 v16, v16, v24
    v_add_f32 v17, v17, v25
    v_add_f32 v18, v18, v26
    v_add_f32 v19, v19, v27
    v_add_f32 v20, v20, v28
    v_add_f32 v21, v21, v29
    v_add_f32 v22, v22, v30
    v_add_f32 v23, v23, v31
    v_add_f32 v16, v16, v20
    v_add_f32 v17, v17, v21
    v_add_f32 v18, v18, v22
    v_add_f32 v19, v19, v23
    v_add_f32 v16, v16, v18
    v_add_f32 v17, v17, v19
    v_add_f32 v16, v16, v17
    v_mul_f32 v16, 0x37800000, v16
    v_cvt_pk_bf16_f32 v16, v16, v16
    v_lshlrev_b32 v16, 16, v16
    ds_write_b32 v6, v16 offset:24576
    s_waitcnt lgkmcnt(0)
L_b4:
    s_barrier
    v_and_b32 v6, 63, v0
    v_lshlrev_b32 v6, 2, v6
    ds_read_b32 v16, v6 offset:24576
    ds_read_b32 v17, v6 offset:24832
    ds_read_b32 v18, v6 offset:25088
    ds_read_b32 v19, v6 offset:25344
    ds_read_b32 v20, v6 offset:25600
    ds_read_b32 v21, v6 offset:25856
    s_waitcnt lgkmcnt(0)
    v_mul_f32 v8, v16, v96
    v_mul_f32 v9, v16, v97
    v_fmac_f32 v8, v17, v98
    v_fmac_f32 v9, v17, v99
    v_fmac_f32 v8, v18, v100
    v_fmac_f32 v9, v18, v101
    v_fmac_f32 v8, v19, v102
    v_fmac_f32 v9, v19, v103
    v_fmac_f32 v8, v20, v104
    v_fmac_f32 v9, v20, v105
    v_fmac_f32 v8, v21, v106
    v_fmac_f32 v9, v21, v107
    s_nop 1
    v_add_f32_dpp v8, v8, v8 row_shr:1 row_mask:0xf bank_mask:0xf bound_ctrl:0
    v_add_f32_dpp v9, v9, v9 row_shr:1 row_mask:0xf bank_mask:0xf bound_ctrl:0
    s_nop 0
    v_add_f32_dpp v8, v8, v8 row_shr:2 row_mask:0xf bank_mask:0xf bound_ctrl:0
    v_add_f32_dpp v9, v9, v9 row_shr:2 row_mask:0xf bank_mask:0xf bound_ctrl:0
    s_nop 0
    v_add_f32_dpp v8, v8, v8 row_shr:4 row_mask:0xf bank_mask:0xf bound_ctrl:0
    v_add_f32_dpp v9, v9, v9 row_shr:4 row_mask:0xf bank_mask:0xf bound_ctrl:0
    s_nop 0
    v_add_f32_dpp v8, v8, v8 row_shr:8 row_mask:0xf bank_mask:0xf bound_ctrl:0
    v_add_f32_dpp v9, v9, v9 row_shr:8 row_mask:0xf bank_mask:0xf bound_ctrl:0
    s_nop 0
    v_add_f32_dpp v8, v8, v8 row_bcast:15 row_mask:0xa bank_mask:0xf
    v_add_f32_dpp v9, v9, v9 row_bcast:15 row_mask:0xa bank_mask:0xf
    s_nop 0
    v_add_f32_dpp v8, v8, v8 row_bcast:31 row_mask:0xc bank_mask:0xf
    v_add_f32_dpp v9, v9, v9 row_bcast:31 row_mask:0xc bank_mask:0xf
    v_cvt_pk_bf16_f32 v10, v8, v9
    v_lshlrev_b32 v8, 16, v10
    v_and_b32 v9, 0xffff0000, v10
    v_mul_f32 v10, 0xbfb8aa3b, v8
    v_mul_f32 v11, 0xbfb8aa3b, v9
    v_exp_f32 v10, v10
    v_exp_f32 v11, v11
    v_add_f32 v10, 1.0, v10
    v_add_f32 v11, 1.0, v11
    v_rcp_f32 v10, v10
    v_rcp_f32 v11, v11
    v_mul_f32 v8, v8, v10
    v_mul_f32 v9, v9, v11
    v_cvt_pk_bf16_f32 v10, v8, v9
    v_lshlrev_b32 v8, 16, v10
    v_and_b32 v9, 0xffff0000, v10
    s_lshl_b32 s33, s31, 3
    v_mov_b32 v10, s33
    v_and_b32 v11, 63, v0
    v_cmp_eq_u32 vcc, 63, v11
    s_and_saveexec_b64 s[34:35], vcc
    ds_write_b64 v10, v[8:9] offset:26112
    s_mov_b64 exec, s[34:35]
    s_waitcnt lgkmcnt(0)
    s_barrier
    s_cmp_ge_u32 s31, 6
    s_cbranch_scc1 L_b6
    v_mov_b32 v6, 0
    ds_read_b128 v[16:19], v6 offset:26112
    ds_read_b128 v[20:23], v6 offset:26128
    ds_read_b128 v[24:27], v6 offset:26144
    ds_read_b128 v[28:31], v6 offset:26160
    ds_read_b128 v[96:99], v6 offset:26176
    ds_read_b128 v[100:103], v6 offset:26192
    s_waitcnt lgkmcnt(0)
    v_mul_f32 v7, v16, v108
    v_mul_f32 v8, v17, v109
    v_fmac_f32 v7, v18, v110
    v_fmac_f32 v8, v19, v111
    v_fmac_f32 v7, v20, v112
    v_fmac_f32 v8, v21, v113
    v_fmac_f32 v7, v22, v114
    v_fmac_f32 v8, v23, v115
    v_fmac_f32 v7, v24, v116
    v_fmac_f32 v8, v25, v117
    v_fmac_f32 v7, v26, v118
    v_fmac_f32 v8, v27, v119
    v_fmac_f32 v7, v28, v120
    v_fmac_f32 v8, v29, v121
    v_fmac_f32 v7, v30, v122
    v_fmac_f32 v8, v31, v123
    v_fmac_f32 v7, v96, v124
    v_fmac_f32 v8, v97, v125
    v_fmac_f32 v7, v98, v126
    v_fmac_f32 v8, v99, v127
    v_fmac_f32 v7, v100, v128
    v_fmac_f32 v8, v101, v129
    v_fmac_f32 v7, v102, v130
    v_fmac_f32 v8, v103, v131
    v_add_f32 v7, v7, v8
    v_cvt_pk_bf16_f32 v7, v7, v7
    v_lshlrev_b32 v7, 16, v7
    v_mul_f32 v7, 0xbfb8aa3b, v7
    v_exp_f32 v7, v7
    s_nop 0
    v_add_f32 v7, 1.0, v7
    v_rcp_f32 v7, v7
    s_nop 0
    v_cvt_pk_bf16_f32 v7, v7, v7
    v_lshlrev_b32 v7, 16, v7
    v_lshlrev_b32 v8, 2, v0
    ds_write_b32 v8, v7 offset:26240
    s_waitcnt lgkmcnt(0)
L_b6:
    s_barrier
    v_lshlrev_b32 v6, 5, v3
    ds_read_b128 v[24:27], v6 offset:26240
    ds_read_b128 v[28:31], v6 offset:26256
    s_waitcnt lgkmcnt(0)
    v_lshlrev_b32 v6, 16, v32
    v_and_b32 v7, 0xffff0000, v32
    v_pk_mul_f32 v[6:7], v[6:7], v[24:25]
    v_cvt_pk_bf16_f32 v32, v6, v7
    v_lshlrev_b32 v8, 16, v33
    v_and_b32 v9, 0xffff0000, v33
    v_pk_mul_f32 v[8:9], v[8:9], v[26:27]
    v_cvt_pk_bf16_f32 v33, v8, v9
    v_lshlrev_b32 v6, 16, v34
    v_and_b32 v7, 0xffff0000, v34
    v_pk_mul_f32 v[6:7], v[6:7], v[28:29]
    v_cvt_pk_bf16_f32 v34, v6, v7
    v_lshlrev_b32 v8, 16, v35
    v_and_b32 v9, 0xffff0000, v35
    v_pk_mul_f32 v[8:9], v[8:9], v[30:31]
    v_cvt_pk_bf16_f32 v35, v8, v9
    buffer_store_dwordx4 v[32:35], v1, s[8:11], s48 offen
    v_lshlrev_b32 v6, 16, v36
    v_and_b32 v7, 0xffff0000, v36
    v_pk_mul_f32 v[6:7], v[6:7], v[24:25]
    v_cvt_pk_bf16_f32 v36, v6, v7
    v_lshlrev_b32 v8, 16, v37
    v_and_b32 v9, 0xffff0000, v37
    v_pk_mul_f32 v[8:9], v[8:9], v[26:27]
    v_cvt_pk_bf16_f32 v37, v8, v9
    v_lshlrev_b32 v6, 16, v38
    v_and_b32 v7, 0xffff0000, v38
    v_pk_mul_f32 v[6:7], v[6:7], v[28:29]
    v_cvt_pk_bf16_f32 v38, v6, v7
    v_lshlrev_b32 v8, 16, v39
    v_and_b32 v9, 0xffff0000, v39
    v_pk_mul_f32 v[8:9], v[8:9], v[30:31]
    v_cvt_pk_bf16_f32 v39, v8, v9
    buffer_store_dwordx4 v[36:39], v1, s[8:11], s49 offen
    v_lshlrev_b32 v6, 16, v40
    v_and_b32 v7, 0xffff0000, v40
    v_pk_mul_f32 v[6:7], v[6:7], v[24:25]
    v_cvt_pk_bf16_f32 v40, v6, v7
    v_lshlrev_b32 v8, 16, v41
    v_and_b32 v9, 0xffff0000, v41
    v_pk_mul_f32 v[8:9], v[8:9], v[26:27]
    v_cvt_pk_bf16_f32 v41, v8, v9
    v_lshlrev_b32 v6, 16, v42
    v_and_b32 v7, 0xffff0000, v42
    v_pk_mul_f32 v[6:7], v[6:7], v[28:29]
    v_cvt_pk_bf16_f32 v42, v6, v7
    v_lshlrev_b32 v8, 16, v43
    v_and_b32 v9, 0xffff0000, v43
    v_pk_mul_f32 v[8:9], v[8:9], v[30:31]
    v_cvt_pk_bf16_f32 v43, v8, v9
    buffer_store_dwordx4 v[40:43], v1, s[8:11], s50 offen
    v_lshlrev_b32 v6, 16, v44
    v_and_b32 v7, 0xffff0000, v44
    v_pk_mul_f32 v[6:7], v[6:7], v[24:25]
    v_cvt_pk_bf16_f32 v44, v6, v7
    v_lshlrev_b32 v8, 16, v45
    v_and_b32 v9, 0xffff0000, v45
    v_pk_mul_f32 v[8:9], v[8:9], v[26:27]
    v_cvt_pk_bf16_f32 v45, v8, v9
    v_lshlrev_b32 v6, 16, v46
    v_and_b32 v7, 0xffff0000, v46
    v_pk_mul_f32 v[6:7], v[6:7], v[28:29]
    v_cvt_pk_bf16_f32 v46, v6, v7
    v_lshlrev_b32 v8, 16, v47
    v_and_b32 v9, 0xffff0000, v47
    v_pk_mul_f32 v[8:9], v[8:9], v[30:31]
    v_cvt_pk_bf16_f32 v47, v8, v9
    buffer_store_dwordx4 v[44:47], v1, s[8:11], s51 offen
    v_lshlrev_b32 v6, 16, v48
    v_and_b32 v7, 0xffff0000, v48
    v_pk_mul_f32 v[6:7], v[6:7], v[24:25]
    v_cvt_pk_bf16_f32 v48, v6, v7
    v_lshlrev_b32 v8, 16, v49
    v_and_b32 v9, 0xffff0000, v49
    v_pk_mul_f32 v[8:9], v[8:9], v[26:27]
    v_cvt_pk_bf16_f32 v49, v8, v9
    v_lshlrev_b32 v6, 16, v50
    v_and_b32 v7, 0xffff0000, v50
    v_pk_mul_f32 v[6:7], v[6:7], v[28:29]
    v_cvt_pk_bf16_f32 v50, v6, v7
    v_lshlrev_b32 v8, 16, v51
    v_and_b32 v9, 0xffff0000, v51
    v_pk_mul_f32 v[8:9], v[8:9], v[30:31]
    v_cvt_pk_bf16_f32 v51, v8, v9
    buffer_store_dwordx4 v[48:51], v1, s[8:11], s52 offen
    v_lshlrev_b32 v6, 16, v52
    v_and_b32 v7, 0xffff0000, v52
    v_pk_mul_f32 v[6:7], v[6:7], v[24:25]
    v_cvt_pk_bf16_f32 v52, v6, v7
    v_lshlrev_b32 v8, 16, v53
    v_and_b32 v9, 0xffff0000, v53
    v_pk_mul_f32 v[8:9], v[8:9], v[26:27]
    v_cvt_pk_bf16_f32 v53, v8, v9
    v_lshlrev_b32 v6, 16, v54
    v_and_b32 v7, 0xffff0000, v54
    v_pk_mul_f32 v[6:7], v[6:7], v[28:29]
    v_cvt_pk_bf16_f32 v54, v6, v7
    v_lshlrev_b32 v8, 16, v55
    v_and_b32 v9, 0xffff0000, v55
    v_pk_mul_f32 v[8:9], v[8:9], v[30:31]
    v_cvt_pk_bf16_f32 v55, v8, v9
    buffer_store_dwordx4 v[52:55], v1, s[8:11], s53 offen
    v_lshlrev_b32 v6, 16, v56
    v_and_b32 v7, 0xffff0000, v56
    v_pk_mul_f32 v[6:7], v[6:7], v[24:25]
    v_cvt_pk_bf16_f32 v56, v6, v7
    v_lshlrev_b32 v8, 16, v57
    v_and_b32 v9, 0xffff0000, v57
    v_pk_mul_f32 v[8:9], v[8:9], v[26:27]
    v_cvt_pk_bf16_f32 v57, v8, v9
    v_lshlrev_b32 v6, 16, v58
    v_and_b32 v7, 0xffff0000, v58
    v_pk_mul_f32 v[6:7], v[6:7], v[28:29]
    v_cvt_pk_bf16_f32 v58, v6, v7
    v_lshlrev_b32 v8, 16, v59
    v_and_b32 v9, 0xffff0000, v59
    v_pk_mul_f32 v[8:9], v[8:9], v[30:31]
    v_cvt_pk_bf16_f32 v59, v8, v9
    buffer_store_dwordx4 v[56:59], v1, s[8:11], s54 offen
    v_lshlrev_b32 v6, 16, v60
    v_and_b32 v7, 0xffff0000, v60
    v_pk_mul_f32 v[6:7], v[6:7], v[24:25]
    v_cvt_pk_bf16_f32 v60, v6, v7
    v_lshlrev_b32 v8, 16, v61
    v_and_b32 v9, 0xffff0000, v61
    v_pk_mul_f32 v[8:9], v[8:9], v[26:27]
    v_cvt_pk_bf16_f32 v61, v8, v9
    v_lshlrev_b32 v6, 16, v62
    v_and_b32 v7, 0xffff0000, v62
    v_pk_mul_f32 v[6:7], v[6:7], v[28:29]
    v_cvt_pk_bf16_f32 v62, v6, v7
    v_lshlrev_b32 v8, 16, v63
    v_and_b32 v9, 0xffff0000, v63
    v_pk_mul_f32 v[8:9], v[8:9], v[30:31]
    v_cvt_pk_bf16_f32 v63, v8, v9
    buffer_store_dwordx4 v[60:63], v1, s[8:11], s55 offen
    v_lshlrev_b32 v6, 16, v64
    v_and_b32 v7, 0xffff0000, v64
    v_pk_mul_f32 v[6:7], v[6:7], v[24:25]
    v_cvt_pk_bf16_f32 v64, v6, v7
    v_lshlrev_b32 v8, 16, v65
    v_and_b32 v9, 0xffff0000, v65
    v_pk_mul_f32 v[8:9], v[8:9], v[26:27]
    v_cvt_pk_bf16_f32 v65, v8, v9
    v_lshlrev_b32 v6, 16, v66
    v_and_b32 v7, 0xffff0000, v66
    v_pk_mul_f32 v[6:7], v[6:7], v[28:29]
    v_cvt_pk_bf16_f32 v66, v6, v7
    v_lshlrev_b32 v8, 16, v67
    v_and_b32 v9, 0xffff0000, v67
    v_pk_mul_f32 v[8:9], v[8:9], v[30:31]
    v_cvt_pk_bf16_f32 v67, v8, v9
    buffer_store_dwordx4 v[64:67], v1, s[8:11], s56 offen
    v_lshlrev_b32 v6, 16, v68
    v_and_b32 v7, 0xffff0000, v68
    v_pk_mul_f32 v[6:7], v[6:7], v[24:25]
    v_cvt_pk_bf16_f32 v68, v6, v7
    v_lshlrev_b32 v8, 16, v69
    v_and_b32 v9, 0xffff0000, v69
    v_pk_mul_f32 v[8:9], v[8:9], v[26:27]
    v_cvt_pk_bf16_f32 v69, v8, v9
    v_lshlrev_b32 v6, 16, v70
    v_and_b32 v7, 0xffff0000, v70
    v_pk_mul_f32 v[6:7], v[6:7], v[28:29]
    v_cvt_pk_bf16_f32 v70, v6, v7
    v_lshlrev_b32 v8, 16, v71
    v_and_b32 v9, 0xffff0000, v71
    v_pk_mul_f32 v[8:9], v[8:9], v[30:31]
    v_cvt_pk_bf16_f32 v71, v8, v9
    buffer_store_dwordx4 v[68:71], v1, s[8:11], s57 offen
    v_lshlrev_b32 v6, 16, v72
    v_and_b32 v7, 0xffff0000, v72
    v_pk_mul_f32 v[6:7], v[6:7], v[24:25]
    v_cvt_pk_bf16_f32 v72, v6, v7
    v_lshlrev_b32 v8, 16, v73
    v_and_b32 v9, 0xffff0000, v73
    v_pk_mul_f32 v[8:9], v[8:9], v[26:27]
    v_cvt_pk_bf16_f32 v73, v8, v9
    v_lshlrev_b32 v6, 16, v74
    v_and_b32 v7, 0xffff0000, v74
    v_pk_mul_f32 v[6:7], v[6:7], v[28:29]
    v_cvt_pk_bf16_f32 v74, v6, v7
    v_lshlrev_b32 v8, 16, v75
    v_and_b32 v9, 0xffff0000, v75
    v_pk_mul_f32 v[8:9], v[8:9], v[30:31]
    v_cvt_pk_bf16_f32 v75, v8, v9
    buffer_store_dwordx4 v[72:75], v1, s[8:11], s58 offen
    v_lshlrev_b32 v6, 16, v76
    v_and_b32 v7, 0xffff0000, v76
    v_pk_mul_f32 v[6:7], v[6:7], v[24:25]
    v_cvt_pk_bf16_f32 v76, v6, v7
    v_lshlrev_b32 v8, 16, v77
    v_and_b32 v9, 0xffff0000, v77
    v_pk_mul_f32 v[8:9], v[8:9], v[26:27]
    v_cvt_pk_bf16_f32 v77, v8, v9
    v_lshlrev_b32 v6, 16, v78
    v_and_b32 v7, 0xffff0000, v78
    v_pk_mul_f32 v[6:7], v[6:7], v[28:29]
    v_cvt_pk_bf16_f32 v78, v6, v7
    v_lshlrev_b32 v8, 16, v79
    v_and_b32 v9, 0xffff0000, v79
    v_pk_mul_f32 v[8:9], v[8:9], v[30:31]
    v_cvt_pk_bf16_f32 v79, v8, v9
    buffer_store_dwordx4 v[76:79], v1, s[8:11], s59 offen
    v_lshlrev_b32 v6, 16, v80
    v_and_b32 v7, 0xffff0000, v80
    v_pk_mul_f32 v[6:7], v[6:7], v[24:25]
    v_cvt_pk_bf16_f32 v80, v6, v7
    v_lshlrev_b32 v8, 16, v81
    v_and_b32 v9, 0xffff0000, v81
    v_pk_mul_f32 v[8:9], v[8:9], v[26:27]
    v_cvt_pk_bf16_f32 v81, v8, v9
    v_lshlrev_b32 v6, 16, v82
    v_and_b32 v7, 0xffff0000, v82
    v_pk_mul_f32 v[6:7], v[6:7], v[28:29]
    v_cvt_pk_bf16_f32 v82, v6, v7
    v_lshlrev_b32 v8, 16, v83
    v_and_b32 v9, 0xffff0000, v83
    v_pk_mul_f32 v[8:9], v[8:9], v[30:31]
    v_cvt_pk_bf16_f32 v83, v8, v9
    buffer_store_dwordx4 v[80:83], v1, s[8:11], s60 offen
    v_lshlrev_b32 v6, 16, v84
    v_and_b32 v7, 0xffff0000, v84
    v_pk_mul_f32 v[6:7], v[6:7], v[24:25]
    v_cvt_pk_bf16_f32 v84, v6, v7
    v_lshlrev_b32 v8, 16, v85
    v_and_b32 v9, 0xffff0000, v85
    v_pk_mul_f32 v[8:9], v[8:9], v[26:27]
    v_cvt_pk_bf16_f32 v85, v8, v9
    v_lshlrev_b32 v6, 16, v86
    v_and_b32 v7, 0xffff0000, v86
    v_pk_mul_f32 v[6:7], v[6:7], v[28:29]
    v_cvt_pk_bf16_f32 v86, v6, v7
    v_lshlrev_b32 v8, 16, v87
    v_and_b32 v9, 0xffff0000, v87
    v_pk_mul_f32 v[8:9], v[8:9], v[30:31]
    v_cvt_pk_bf16_f32 v87, v8, v9
    buffer_store_dwordx4 v[84:87], v1, s[8:11], s61 offen
    v_lshlrev_b32 v6, 16, v88
    v_and_b32 v7, 0xffff0000, v88
    v_pk_mul_f32 v[6:7], v[6:7], v[24:25]
    v_cvt_pk_bf16_f32 v88, v6, v7
    v_lshlrev_b32 v8, 16, v89
    v_and_b32 v9, 0xffff0000, v89
    v_pk_mul_f32 v[8:9], v[8:9], v[26:27]
    v_cvt_pk_bf16_f32 v89, v8, v9
    v_lshlrev_b32 v6, 16, v90
    v_and_b32 v7, 0xffff0000, v90
    v_pk_mul_f32 v[6:7], v[6:7], v[28:29]
    v_cvt_pk_bf16_f32 v90, v6, v7
    v_lshlrev_b32 v8, 16, v91
    v_and_b32 v9, 0xffff0000, v91
    v_pk_mul_f32 v[8:9], v[8:9], v[30:31]
    v_cvt_pk_bf16_f32 v91, v8, v9
    buffer_store_dwordx4 v[88:91], v1, s[8:11], s62 offen
    v_lshlrev_b32 v6, 16, v92
    v_and_b32 v7, 0xffff0000, v92
    v_pk_mul_f32 v[6:7], v[6:7], v[24:25]
    v_cvt_pk_bf16_f32 v92, v6, v7
    v_lshlrev_b32 v8, 16, v93
    v_and_b32 v9, 0xffff0000, v93
    v_pk_mul_f32 v[8:9], v[8:9], v[26:27]
    v_cvt_pk_bf16_f32 v93, v8, v9
    v_lshlrev_b32 v6, 16, v94
    v_and_b32 v7, 0xffff0000, v94
    v_pk_mul_f32 v[6:7], v[6:7], v[28:29]
    v_cvt_pk_bf16_f32 v94, v6, v7
    v_lshlrev_b32 v8, 16, v95
    v_and_b32 v9, 0xffff0000, v95
    v_pk_mul_f32 v[8:9], v[8:9], v[30:31]
    v_cvt_pk_bf16_f32 v95, v8, v9
    buffer_store_dwordx4 v[92:95], v1, s[8:11], s63 offen
L_end:
    s_endpgm
.section .rodata,"a"
.p2align 6
.amdhsa_kernel standalone__channel_attn_se__vision_kernel
  .amdhsa_next_free_vgpr 136
  .amdhsa_next_free_sgpr 80
  .amdhsa_accum_offset 136
  .amdhsa_group_segment_fixed_size 0
  .amdhsa_kernarg_size 48
  .amdhsa_user_sgpr_count 2
  .amdhsa_user_sgpr_kernarg_segment_ptr 1
  .amdhsa_system_sgpr_workgroup_id_x 1
  .amdhsa_float_denorm_mode_32 3
.end_amdhsa_kernel
```

```asm
; @launch grid=(256,1,1) block=(768,1,1) lds=27776
.amdgcn_target "amdgcn-amd-amdhsa--gfx950"
.text
.globl standalone__channel_attn_se__vision_kernel
.p2align 8
.type standalone__channel_attn_se__vision_kernel,@function
standalone__channel_attn_se__vision_kernel:
    s_cmp_ge_u32 s2, 256
    s_cbranch_scc1 L_end
    s_load_dwordx4 s[36:39], s[0:1], 0
    s_load_dwordx4 s[40:43], s[0:1], 16
    s_load_dwordx4 s[44:47], s[0:1], 32
    v_lshlrev_b32 v1, 4, v0
    v_lshrrev_b32 v6, 6, v0
    s_mul_i32 s28, s2, 196608
    s_add_u32 s48, s28, 0
    s_add_u32 s49, s28, 12288
    s_add_u32 s50, s28, 24576
    s_add_u32 s51, s28, 36864
    s_add_u32 s52, s28, 49152
    s_add_u32 s53, s28, 61440
    s_add_u32 s54, s28, 73728
    s_add_u32 s55, s28, 86016
    s_add_u32 s56, s28, 98304
    s_add_u32 s57, s28, 110592
    s_add_u32 s58, s28, 122880
    s_add_u32 s59, s28, 135168
    s_add_u32 s60, s28, 147456
    s_add_u32 s61, s28, 159744
    s_add_u32 s62, s28, 172032
    s_add_u32 s63, s28, 184320
    v_readfirstlane_b32 s31, v6
    s_mov_b32 s64, 0
    s_mov_b32 s65, 3072
    s_mov_b32 s66, 6144
    s_mov_b32 s67, 9216
    s_mov_b32 s68, 12288
    s_mov_b32 s69, 15360
    s_mov_b32 s76, 0
    s_mov_b32 s77, 4096
    s_mov_b32 s78, 8192
    s_mov_b32 s79, 12288
    s_mov_b32 s80, 16384
    s_mov_b32 s81, 20480
    s_mov_b32 s82, 24576
    s_mov_b32 s83, 28672
    s_mov_b32 s84, 32768
    s_mov_b32 s85, 36864
    s_mov_b32 s86, 40960
    s_mov_b32 s87, 45056
    s_waitcnt lgkmcnt(0)
    s_mov_b32 s4, s36
    s_mov_b32 s5, s37
    s_mov_b32 s6, 50331648
    s_mov_b32 s7, 0x00020000
    s_mov_b32 s8, s42
    s_mov_b32 s9, s43
    s_mov_b32 s10, 50331648
    s_mov_b32 s11, 0x00020000
    s_mov_b32 s12, s46
    s_mov_b32 s13, s47
    s_mov_b32 s14, 49152
    s_mov_b32 s15, 0x00020000
    s_mov_b32 s16, s44
    s_mov_b32 s17, s45
    s_mov_b32 s18, 256
    s_mov_b32 s19, 0x00020000
    s_mov_b32 s20, s38
    s_mov_b32 s21, s39
    s_mov_b32 s22, 18432
    s_mov_b32 s23, 0x00020000
    s_mov_b32 s24, s40
    s_mov_b32 s25, s41
    s_mov_b32 s26, 18432
    s_mov_b32 s27, 0x00020000
    s_lshl_b32 s33, s2, 4
    s_add_u32 s33, s33, s31
    s_cmp_lg_u32 s33, 11
    s_cbranch_scc1 L_nozero
    v_mov_b32 v6, 0
    v_mov_b32 v7, 0
    v_mov_b32 v8, 0
    v_mov_b32 v9, 0
    v_and_b32 v10, 63, v0
    v_lshlrev_b32 v10, 4, v10
    buffer_store_dwordx4 v[6:9], v10, s[12:15], s76 offen offset:0 sc1
    buffer_store_dwordx4 v[6:9], v10, s[12:15], s76 offen offset:1024 sc1
    buffer_store_dwordx4 v[6:9], v10, s[12:15], s76 offen offset:2048 sc1
    buffer_store_dwordx4 v[6:9], v10, s[12:15], s76 offen offset:3072 sc1
    buffer_store_dwordx4 v[6:9], v10, s[12:15], s77 offen offset:0 sc1
    buffer_store_dwordx4 v[6:9], v10, s[12:15], s77 offen offset:1024 sc1
    buffer_store_dwordx4 v[6:9], v10, s[12:15], s77 offen offset:2048 sc1
    buffer_store_dwordx4 v[6:9], v10, s[12:15], s77 offen offset:3072 sc1
    buffer_store_dwordx4 v[6:9], v10, s[12:15], s78 offen offset:0 sc1
    buffer_store_dwordx4 v[6:9], v10, s[12:15], s78 offen offset:1024 sc1
    buffer_store_dwordx4 v[6:9], v10, s[12:15], s78 offen offset:2048 sc1
    buffer_store_dwordx4 v[6:9], v10, s[12:15], s78 offen offset:3072 sc1
    buffer_store_dwordx4 v[6:9], v10, s[12:15], s79 offen offset:0 sc1
    buffer_store_dwordx4 v[6:9], v10, s[12:15], s79 offen offset:1024 sc1
    buffer_store_dwordx4 v[6:9], v10, s[12:15], s79 offen offset:2048 sc1
    buffer_store_dwordx4 v[6:9], v10, s[12:15], s79 offen offset:3072 sc1
    buffer_store_dwordx4 v[6:9], v10, s[12:15], s80 offen offset:0 sc1
    buffer_store_dwordx4 v[6:9], v10, s[12:15], s80 offen offset:1024 sc1
    buffer_store_dwordx4 v[6:9], v10, s[12:15], s80 offen offset:2048 sc1
    buffer_store_dwordx4 v[6:9], v10, s[12:15], s80 offen offset:3072 sc1
    buffer_store_dwordx4 v[6:9], v10, s[12:15], s81 offen offset:0 sc1
    buffer_store_dwordx4 v[6:9], v10, s[12:15], s81 offen offset:1024 sc1
    buffer_store_dwordx4 v[6:9], v10, s[12:15], s81 offen offset:2048 sc1
    buffer_store_dwordx4 v[6:9], v10, s[12:15], s81 offen offset:3072 sc1
    buffer_store_dwordx4 v[6:9], v10, s[12:15], s82 offen offset:0 sc1
    buffer_store_dwordx4 v[6:9], v10, s[12:15], s82 offen offset:1024 sc1
    buffer_store_dwordx4 v[6:9], v10, s[12:15], s82 offen offset:2048 sc1
    buffer_store_dwordx4 v[6:9], v10, s[12:15], s82 offen offset:3072 sc1
    buffer_store_dwordx4 v[6:9], v10, s[12:15], s83 offen offset:0 sc1
    buffer_store_dwordx4 v[6:9], v10, s[12:15], s83 offen offset:1024 sc1
    buffer_store_dwordx4 v[6:9], v10, s[12:15], s83 offen offset:2048 sc1
    buffer_store_dwordx4 v[6:9], v10, s[12:15], s83 offen offset:3072 sc1
    buffer_store_dwordx4 v[6:9], v10, s[12:15], s84 offen offset:0 sc1
    buffer_store_dwordx4 v[6:9], v10, s[12:15], s84 offen offset:1024 sc1
    buffer_store_dwordx4 v[6:9], v10, s[12:15], s84 offen offset:2048 sc1
    buffer_store_dwordx4 v[6:9], v10, s[12:15], s84 offen offset:3072 sc1
    buffer_store_dwordx4 v[6:9], v10, s[12:15], s85 offen offset:0 sc1
    buffer_store_dwordx4 v[6:9], v10, s[12:15], s85 offen offset:1024 sc1
    buffer_store_dwordx4 v[6:9], v10, s[12:15], s85 offen offset:2048 sc1
    buffer_store_dwordx4 v[6:9], v10, s[12:15], s85 offen offset:3072 sc1
    buffer_store_dwordx4 v[6:9], v10, s[12:15], s86 offen offset:0 sc1
    buffer_store_dwordx4 v[6:9], v10, s[12:15], s86 offen offset:1024 sc1
    buffer_store_dwordx4 v[6:9], v10, s[12:15], s86 offen offset:2048 sc1
    buffer_store_dwordx4 v[6:9], v10, s[12:15], s86 offen offset:3072 sc1
    buffer_store_dwordx4 v[6:9], v10, s[12:15], s87 offen offset:0 sc1
    buffer_store_dwordx4 v[6:9], v10, s[12:15], s87 offen offset:1024 sc1
    buffer_store_dwordx4 v[6:9], v10, s[12:15], s87 offen offset:2048 sc1
    buffer_store_dwordx4 v[6:9], v10, s[12:15], s87 offen offset:3072 sc1
    s_waitcnt vmcnt(0)
    v_mov_b32 v6, 1
    v_mov_b32 v7, 0
    buffer_store_dword v6, v7, s[16:19], 0 offen sc1
L_nozero:
    buffer_load_dwordx4 v[32:35], v1, s[4:7], s48 offen nt
    buffer_load_dwordx4 v[36:39], v1, s[4:7], s49 offen nt
    buffer_load_dwordx4 v[40:43], v1, s[4:7], s50 offen nt
    buffer_load_dwordx4 v[44:47], v1, s[4:7], s51 offen nt
    buffer_load_dwordx4 v[48:51], v1, s[4:7], s52 offen nt
    buffer_load_dwordx4 v[52:55], v1, s[4:7], s53 offen nt
    buffer_load_dwordx4 v[56:59], v1, s[4:7], s54 offen nt
    buffer_load_dwordx4 v[60:63], v1, s[4:7], s55 offen nt
    buffer_load_dwordx4 v[64:67], v1, s[4:7], s56 offen nt
    buffer_load_dwordx4 v[68:71], v1, s[4:7], s57 offen nt
    buffer_load_dwordx4 v[72:75], v1, s[4:7], s58 offen nt
    buffer_load_dwordx4 v[76:79], v1, s[4:7], s59 offen nt
    buffer_load_dwordx4 v[80:83], v1, s[4:7], s60 offen nt
    buffer_load_dwordx4 v[84:87], v1, s[4:7], s61 offen nt
    buffer_load_dwordx4 v[88:91], v1, s[4:7], s62 offen nt
    buffer_load_dwordx4 v[92:95], v1, s[4:7], s63 offen nt
    v_mul_u32_u24 v2, 0x556, v0
    v_lshrrev_b32 v2, 16, v2
    v_mul_u32_u24 v3, 48, v2
    v_sub_u32 v3, v0, v3
    v_and_b32 v6, 63, v0
    v_mul_u32_u24 v4, 48, v6
    s_lshl_b32 s32, s31, 2
    v_add_u32 v4, s32, v4
    v_lshlrev_b32 v5, 1, v0
    buffer_load_dword v96, v4, s[20:23], s64 offen
    buffer_load_dword v97, v4, s[20:23], s65 offen
    buffer_load_dword v98, v4, s[20:23], s66 offen
    buffer_load_dword v99, v4, s[20:23], s67 offen
    buffer_load_dword v100, v4, s[20:23], s68 offen
    buffer_load_dword v101, v4, s[20:23], s69 offen
    buffer_load_ushort v108, v5, s[24:27], s64 offen offset:0
    buffer_load_ushort v109, v5, s[24:27], s64 offen offset:768
    buffer_load_ushort v110, v5, s[24:27], s64 offen offset:1536
    buffer_load_ushort v111, v5, s[24:27], s64 offen offset:2304
    buffer_load_ushort v112, v5, s[24:27], s65 offen offset:0
    buffer_load_ushort v113, v5, s[24:27], s65 offen offset:768
    buffer_load_ushort v114, v5, s[24:27], s65 offen offset:1536
    buffer_load_ushort v115, v5, s[24:27], s65 offen offset:2304
    buffer_load_ushort v116, v5, s[24:27], s66 offen offset:0
    buffer_load_ushort v117, v5, s[24:27], s66 offen offset:768
    buffer_load_ushort v118, v5, s[24:27], s66 offen offset:1536
    buffer_load_ushort v119, v5, s[24:27], s66 offen offset:2304
    buffer_load_ushort v120, v5, s[24:27], s67 offen offset:0
    buffer_load_ushort v121, v5, s[24:27], s67 offen offset:768
    buffer_load_ushort v122, v5, s[24:27], s67 offen offset:1536
    buffer_load_ushort v123, v5, s[24:27], s67 offen offset:2304
    buffer_load_ushort v124, v5, s[24:27], s68 offen offset:0
    buffer_load_ushort v125, v5, s[24:27], s68 offen offset:768
    buffer_load_ushort v126, v5, s[24:27], s68 offen offset:1536
    buffer_load_ushort v127, v5, s[24:27], s68 offen offset:2304
    buffer_load_ushort v128, v5, s[24:27], s69 offen offset:0
    buffer_load_ushort v129, v5, s[24:27], s69 offen offset:768
    buffer_load_ushort v130, v5, s[24:27], s69 offen offset:1536
    buffer_load_ushort v131, v5, s[24:27], s69 offen offset:2304
    v_mov_b32 v16, 0
    v_mov_b32 v17, 0
    v_mov_b32 v18, 0
    v_mov_b32 v19, 0
    v_mov_b32 v20, 0
    v_mov_b32 v21, 0
    v_mov_b32 v22, 0
    v_mov_b32 v23, 0
    s_waitcnt vmcnt(45)
    v_lshlrev_b32 v6, 16, v32
    v_and_b32 v7, 0xffff0000, v32
    v_pk_add_f32 v[16:17], v[16:17], v[6:7]
    v_lshlrev_b32 v8, 16, v33
    v_and_b32 v9, 0xffff0000, v33
    v_pk_add_f32 v[18:19], v[18:19], v[8:9]
    v_lshlrev_b32 v6, 16, v34
    v_and_b32 v7, 0xffff0000, v34
    v_pk_add_f32 v[20:21], v[20:21], v[6:7]
    v_lshlrev_b32 v8, 16, v35
    v_and_b32 v9, 0xffff0000, v35
    v_pk_add_f32 v[22:23], v[22:23], v[8:9]
    s_waitcnt vmcnt(44)
    v_lshlrev_b32 v6, 16, v36
    v_and_b32 v7, 0xffff0000, v36
    v_pk_add_f32 v[16:17], v[16:17], v[6:7]
    v_lshlrev_b32 v8, 16, v37
    v_and_b32 v9, 0xffff0000, v37
    v_pk_add_f32 v[18:19], v[18:19], v[8:9]
    v_lshlrev_b32 v6, 16, v38
    v_and_b32 v7, 0xffff0000, v38
    v_pk_add_f32 v[20:21], v[20:21], v[6:7]
    v_lshlrev_b32 v8, 16, v39
    v_and_b32 v9, 0xffff0000, v39
    v_pk_add_f32 v[22:23], v[22:23], v[8:9]
    s_waitcnt vmcnt(43)
    v_lshlrev_b32 v6, 16, v40
    v_and_b32 v7, 0xffff0000, v40
    v_pk_add_f32 v[16:17], v[16:17], v[6:7]
    v_lshlrev_b32 v8, 16, v41
    v_and_b32 v9, 0xffff0000, v41
    v_pk_add_f32 v[18:19], v[18:19], v[8:9]
    v_lshlrev_b32 v6, 16, v42
    v_and_b32 v7, 0xffff0000, v42
    v_pk_add_f32 v[20:21], v[20:21], v[6:7]
    v_lshlrev_b32 v8, 16, v43
    v_and_b32 v9, 0xffff0000, v43
    v_pk_add_f32 v[22:23], v[22:23], v[8:9]
    s_waitcnt vmcnt(42)
    v_lshlrev_b32 v6, 16, v44
    v_and_b32 v7, 0xffff0000, v44
    v_pk_add_f32 v[16:17], v[16:17], v[6:7]
    v_lshlrev_b32 v8, 16, v45
    v_and_b32 v9, 0xffff0000, v45
    v_pk_add_f32 v[18:19], v[18:19], v[8:9]
    v_lshlrev_b32 v6, 16, v46
    v_and_b32 v7, 0xffff0000, v46
    v_pk_add_f32 v[20:21], v[20:21], v[6:7]
    v_lshlrev_b32 v8, 16, v47
    v_and_b32 v9, 0xffff0000, v47
    v_pk_add_f32 v[22:23], v[22:23], v[8:9]
    s_waitcnt vmcnt(41)
    v_lshlrev_b32 v6, 16, v48
    v_and_b32 v7, 0xffff0000, v48
    v_pk_add_f32 v[16:17], v[16:17], v[6:7]
    v_lshlrev_b32 v8, 16, v49
    v_and_b32 v9, 0xffff0000, v49
    v_pk_add_f32 v[18:19], v[18:19], v[8:9]
    v_lshlrev_b32 v6, 16, v50
    v_and_b32 v7, 0xffff0000, v50
    v_pk_add_f32 v[20:21], v[20:21], v[6:7]
    v_lshlrev_b32 v8, 16, v51
    v_and_b32 v9, 0xffff0000, v51
    v_pk_add_f32 v[22:23], v[22:23], v[8:9]
    s_waitcnt vmcnt(40)
    v_lshlrev_b32 v6, 16, v52
    v_and_b32 v7, 0xffff0000, v52
    v_pk_add_f32 v[16:17], v[16:17], v[6:7]
    v_lshlrev_b32 v8, 16, v53
    v_and_b32 v9, 0xffff0000, v53
    v_pk_add_f32 v[18:19], v[18:19], v[8:9]
    v_lshlrev_b32 v6, 16, v54
    v_and_b32 v7, 0xffff0000, v54
    v_pk_add_f32 v[20:21], v[20:21], v[6:7]
    v_lshlrev_b32 v8, 16, v55
    v_and_b32 v9, 0xffff0000, v55
    v_pk_add_f32 v[22:23], v[22:23], v[8:9]
    s_waitcnt vmcnt(39)
    v_lshlrev_b32 v6, 16, v56
    v_and_b32 v7, 0xffff0000, v56
    v_pk_add_f32 v[16:17], v[16:17], v[6:7]
    v_lshlrev_b32 v8, 16, v57
    v_and_b32 v9, 0xffff0000, v57
    v_pk_add_f32 v[18:19], v[18:19], v[8:9]
    v_lshlrev_b32 v6, 16, v58
    v_and_b32 v7, 0xffff0000, v58
    v_pk_add_f32 v[20:21], v[20:21], v[6:7]
    v_lshlrev_b32 v8, 16, v59
    v_and_b32 v9, 0xffff0000, v59
    v_pk_add_f32 v[22:23], v[22:23], v[8:9]
    s_waitcnt vmcnt(38)
    v_lshlrev_b32 v6, 16, v60
    v_and_b32 v7, 0xffff0000, v60
    v_pk_add_f32 v[16:17], v[16:17], v[6:7]
    v_lshlrev_b32 v8, 16, v61
    v_and_b32 v9, 0xffff0000, v61
    v_pk_add_f32 v[18:19], v[18:19], v[8:9]
    v_lshlrev_b32 v6, 16, v62
    v_and_b32 v7, 0xffff0000, v62
    v_pk_add_f32 v[20:21], v[20:21], v[6:7]
    v_lshlrev_b32 v8, 16, v63
    v_and_b32 v9, 0xffff0000, v63
    v_pk_add_f32 v[22:23], v[22:23], v[8:9]
    s_waitcnt vmcnt(37)
    v_lshlrev_b32 v6, 16, v64
    v_and_b32 v7, 0xffff0000, v64
    v_pk_add_f32 v[16:17], v[16:17], v[6:7]
    v_lshlrev_b32 v8, 16, v65
    v_and_b32 v9, 0xffff0000, v65
    v_pk_add_f32 v[18:19], v[18:19], v[8:9]
    v_lshlrev_b32 v6, 16, v66
    v_and_b32 v7, 0xffff0000, v66
    v_pk_add_f32 v[20:21], v[20:21], v[6:7]
    v_lshlrev_b32 v8, 16, v67
    v_and_b32 v9, 0xffff0000, v67
    v_pk_add_f32 v[22:23], v[22:23], v[8:9]
    s_waitcnt vmcnt(36)
    v_lshlrev_b32 v6, 16, v68
    v_and_b32 v7, 0xffff0000, v68
    v_pk_add_f32 v[16:17], v[16:17], v[6:7]
    v_lshlrev_b32 v8, 16, v69
    v_and_b32 v9, 0xffff0000, v69
    v_pk_add_f32 v[18:19], v[18:19], v[8:9]
    v_lshlrev_b32 v6, 16, v70
    v_and_b32 v7, 0xffff0000, v70
    v_pk_add_f32 v[20:21], v[20:21], v[6:7]
    v_lshlrev_b32 v8, 16, v71
    v_and_b32 v9, 0xffff0000, v71
    v_pk_add_f32 v[22:23], v[22:23], v[8:9]
    v_mov_b32 v10, 0
    buffer_load_dword v132, v10, s[16:19], 0 offen sc1
    s_waitcnt vmcnt(36)
    v_lshlrev_b32 v6, 16, v72
    v_and_b32 v7, 0xffff0000, v72
    v_pk_add_f32 v[16:17], v[16:17], v[6:7]
    v_lshlrev_b32 v8, 16, v73
    v_and_b32 v9, 0xffff0000, v73
    v_pk_add_f32 v[18:19], v[18:19], v[8:9]
    v_lshlrev_b32 v6, 16, v74
    v_and_b32 v7, 0xffff0000, v74
    v_pk_add_f32 v[20:21], v[20:21], v[6:7]
    v_lshlrev_b32 v8, 16, v75
    v_and_b32 v9, 0xffff0000, v75
    v_pk_add_f32 v[22:23], v[22:23], v[8:9]
    s_waitcnt vmcnt(35)
    v_lshlrev_b32 v6, 16, v76
    v_and_b32 v7, 0xffff0000, v76
    v_pk_add_f32 v[16:17], v[16:17], v[6:7]
    v_lshlrev_b32 v8, 16, v77
    v_and_b32 v9, 0xffff0000, v77
    v_pk_add_f32 v[18:19], v[18:19], v[8:9]
    v_lshlrev_b32 v6, 16, v78
    v_and_b32 v7, 0xffff0000, v78
    v_pk_add_f32 v[20:21], v[20:21], v[6:7]
    v_lshlrev_b32 v8, 16, v79
    v_and_b32 v9, 0xffff0000, v79
    v_pk_add_f32 v[22:23], v[22:23], v[8:9]
    s_waitcnt vmcnt(34)
    v_lshlrev_b32 v6, 16, v80
    v_and_b32 v7, 0xffff0000, v80
    v_pk_add_f32 v[16:17], v[16:17], v[6:7]
    v_lshlrev_b32 v8, 16, v81
    v_and_b32 v9, 0xffff0000, v81
    v_pk_add_f32 v[18:19], v[18:19], v[8:9]
    v_lshlrev_b32 v6, 16, v82
    v_and_b32 v7, 0xffff0000, v82
    v_pk_add_f32 v[20:21], v[20:21], v[6:7]
    v_lshlrev_b32 v8, 16, v83
    v_and_b32 v9, 0xffff0000, v83
    v_pk_add_f32 v[22:23], v[22:23], v[8:9]
    s_waitcnt vmcnt(33)
    v_lshlrev_b32 v6, 16, v84
    v_and_b32 v7, 0xffff0000, v84
    v_pk_add_f32 v[16:17], v[16:17], v[6:7]
    v_lshlrev_b32 v8, 16, v85
    v_and_b32 v9, 0xffff0000, v85
    v_pk_add_f32 v[18:19], v[18:19], v[8:9]
    v_lshlrev_b32 v6, 16, v86
    v_and_b32 v7, 0xffff0000, v86
    v_pk_add_f32 v[20:21], v[20:21], v[6:7]
    v_lshlrev_b32 v8, 16, v87
    v_and_b32 v9, 0xffff0000, v87
    v_pk_add_f32 v[22:23], v[22:23], v[8:9]
    s_waitcnt vmcnt(32)
    v_lshlrev_b32 v6, 16, v88
    v_and_b32 v7, 0xffff0000, v88
    v_pk_add_f32 v[16:17], v[16:17], v[6:7]
    v_lshlrev_b32 v8, 16, v89
    v_and_b32 v9, 0xffff0000, v89
    v_pk_add_f32 v[18:19], v[18:19], v[8:9]
    v_lshlrev_b32 v6, 16, v90
    v_and_b32 v7, 0xffff0000, v90
    v_pk_add_f32 v[20:21], v[20:21], v[6:7]
    v_lshlrev_b32 v8, 16, v91
    v_and_b32 v9, 0xffff0000, v91
    v_pk_add_f32 v[22:23], v[22:23], v[8:9]
    s_waitcnt vmcnt(31)
    v_lshlrev_b32 v6, 16, v92
    v_and_b32 v7, 0xffff0000, v92
    v_pk_add_f32 v[16:17], v[16:17], v[6:7]
    v_lshlrev_b32 v8, 16, v93
    v_and_b32 v9, 0xffff0000, v93
    v_pk_add_f32 v[18:19], v[18:19], v[8:9]
    v_lshlrev_b32 v6, 16, v94
    v_and_b32 v7, 0xffff0000, v94
    v_pk_add_f32 v[20:21], v[20:21], v[6:7]
    v_lshlrev_b32 v8, 16, v95
    v_and_b32 v9, 0xffff0000, v95
    v_pk_add_f32 v[22:23], v[22:23], v[8:9]
    v_lshlrev_b32 v6, 5, v0
    ds_write_b128 v6, v[16:19] offset:0
    ds_write_b128 v6, v[20:23] offset:16
    s_waitcnt vmcnt(0)
    v_and_b32 v107, 0xffff0000, v101
    v_lshlrev_b32 v106, 16, v101
    v_and_b32 v105, 0xffff0000, v100
    v_lshlrev_b32 v104, 16, v100
    v_and_b32 v103, 0xffff0000, v99
    v_lshlrev_b32 v102, 16, v99
    v_and_b32 v101, 0xffff0000, v98
    v_lshlrev_b32 v100, 16, v98
    v_and_b32 v99, 0xffff0000, v97
    v_lshlrev_b32 v98, 16, v97
    v_and_b32 v97, 0xffff0000, v96
    v_lshlrev_b32 v96, 16, v96
    v_lshlrev_b32 v108, 16, v108
    v_lshlrev_b32 v109, 16, v109
    v_lshlrev_b32 v110, 16, v110
    v_lshlrev_b32 v111, 16, v111
    v_lshlrev_b32 v112, 16, v112
    v_lshlrev_b32 v113, 16, v113
    v_lshlrev_b32 v114, 16, v114
    v_lshlrev_b32 v115, 16, v115
    v_lshlrev_b32 v116, 16, v116
    v_lshlrev_b32 v117, 16, v117
    v_lshlrev_b32 v118, 16, v118
    v_lshlrev_b32 v119, 16, v119
    v_lshlrev_b32 v120, 16, v120
    v_lshlrev_b32 v121, 16, v121
    v_lshlrev_b32 v122, 16, v122
    v_lshlrev_b32 v123, 16, v123
    v_lshlrev_b32 v124, 16, v124
    v_lshlrev_b32 v125, 16, v125
    v_lshlrev_b32 v126, 16, v126
    v_lshlrev_b32 v127, 16, v127
    v_lshlrev_b32 v128, 16, v128
    v_lshlrev_b32 v129, 16, v129
    v_lshlrev_b32 v130, 16, v130
    v_lshlrev_b32 v131, 16, v131
    s_cmp_lg_u32 s31, 0
    s_cbranch_scc1 L_zok
    s_mov_b32 s33, 0
L_zpoll:
    v_cmp_ne_u32 vcc, 0, v132
    s_nop 4
    s_cbranch_vccnz L_zok
    s_add_u32 s33, s33, 1
    s_cmp_lt_u32 s33, 400000
    s_cbranch_scc0 L_zok
    s_sleep 1
    v_mov_b32 v10, 0
    buffer_load_dword v132, v10, s[16:19], 0 offen sc1
    s_waitcnt vmcnt(0)
    s_branch L_zpoll
L_zok:
    s_waitcnt lgkmcnt(0)
    s_barrier
    s_cmp_ge_u32 s31, 6
    s_cbranch_scc1 L_b2
    v_lshlrev_b32 v6, 2, v0
    ds_read_b32 v16, v6 offset:0
    ds_read_b32 v17, v6 offset:1536
    ds_read_b32 v18, v6 offset:3072
    ds_read_b32 v19, v6 offset:4608
    ds_read_b32 v20, v6 offset:6144
    ds_read_b32 v21, v6 offset:7680
    ds_read_b32 v22, v6 offset:9216
    ds_read_b32 v23, v6 offset:10752
    ds_read_b32 v24, v6 offset:12288
    ds_read_b32 v25, v6 offset:13824
    ds_read_b32 v26, v6 offset:15360
    ds_read_b32 v27, v6 offset:16896
    ds_read_b32 v28, v6 offset:18432
    ds_read_b32 v29, v6 offset:19968
    ds_read_b32 v30, v6 offset:21504
    ds_read_b32 v31, v6 offset:23040
    s_and_b32 s33, s2, 15
    s_mul_i32 s33, s33, 2048
    v_add_u32 v7, s33, v6
    s_waitcnt lgkmcnt(0)
    v_add_f32 v16, v16, v24
    v_add_f32 v17, v17, v25
    v_add_f32 v18, v18, v26
    v_add_f32 v19, v19, v27
    v_add_f32 v20, v20, v28
    v_add_f32 v21, v21, v29
    v_add_f32 v22, v22, v30
    v_add_f32 v23, v23, v31
    v_add_f32 v16, v16, v20
    v_add_f32 v17, v17, v21
    v_add_f32 v18, v18, v22
    v_add_f32 v19, v19, v23
    v_add_f32 v16, v16, v18
    v_add_f32 v17, v17, v19
    v_add_f32 v16, v16, v17
    buffer_atomic_add_f32 v16, v7, s[12:15], 0 offen
    s_waitcnt vmcnt(0)
L_b2:
    s_barrier
    s_cmp_lg_u32 s31, 0
    s_cbranch_scc1 L_b3
    s_and_b32 s33, s2, 63
    s_lshl_b32 s33, s33, 8
    s_add_u32 s33, s33, 32768
    v_mov_b32 v6, s33
    v_mov_b32 v7, 1
    v_cmp_eq_u32 vcc, 0, v0
    s_and_saveexec_b64 s[34:35], vcc
    buffer_atomic_add v7, v6, s[12:15], 0 offen
    s_mov_b64 exec, s[34:35]
    v_and_b32 v8, 63, v0
    v_lshlrev_b32 v8, 8, v8
    v_add_u32 v8, 32768, v8
    s_mov_b32 s33, 0
    buffer_load_dword v10, v8, s[12:15], 0 offen sc1
L_poll:
    s_waitcnt vmcnt(0)
    v_cmp_ne_u32 vcc, 4, v10
    s_nop 4
    s_cbranch_vccz L_b3
    buffer_load_dword v10, v8, s[12:15], 0 offen sc1
    s_add_u32 s33, s33, 1
    s_cmp_lt_u32 s33, 400000
    s_cbranch_scc1 L_poll
L_b3:
    s_barrier
    s_cmp_ge_u32 s31, 6
    s_cbranch_scc1 L_b4
    v_lshlrev_b32 v6, 2, v0
    buffer_load_dword v16, v6, s[12:15], s76 offen offset:0 sc1
    buffer_load_dword v17, v6, s[12:15], s76 offen offset:2048 sc1
    buffer_load_dword v18, v6, s[12:15], s77 offen offset:0 sc1
    buffer_load_dword v19, v6, s[12:15], s77 offen offset:2048 sc1
    buffer_load_dword v20, v6, s[12:15], s78 offen offset:0 sc1
    buffer_load_dword v21, v6, s[12:15], s78 offen offset:2048 sc1
    buffer_load_dword v22, v6, s[12:15], s79 offen offset:0 sc1
    buffer_load_dword v23, v6, s[12:15], s79 offen offset:2048 sc1
    buffer_load_dword v24, v6, s[12:15], s80 offen offset:0 sc1
    buffer_load_dword v25, v6, s[12:15], s80 offen offset:2048 sc1
    buffer_load_dword v26, v6, s[12:15], s81 offen offset:0 sc1
    buffer_load_dword v27, v6, s[12:15], s81 offen offset:2048 sc1
    buffer_load_dword v28, v6, s[12:15], s82 offen offset:0 sc1
    buffer_load_dword v29, v6, s[12:15], s82 offen offset:2048 sc1
    buffer_load_dword v30, v6, s[12:15], s83 offen offset:0 sc1
    buffer_load_dword v31, v6, s[12:15], s83 offen offset:2048 sc1
    s_waitcnt vmcnt(0)
    v_add_f32 v16, v16, v24
    v_add_f32 v17, v17, v25
    v_add_f32 v18, v18, v26
    v_add_f32 v19, v19, v27
    v_add_f32 v20, v20, v28
    v_add_f32 v21, v21, v29
    v_add_f32 v22, v22, v30
    v_add_f32 v23, v23, v31
    v_add_f32 v16, v16, v20
    v_add_f32 v17, v17, v21
    v_add_f32 v18, v18, v22
    v_add_f32 v19, v19, v23
    v_add_f32 v16, v16, v18
    v_add_f32 v17, v17, v19
    v_add_f32 v16, v16, v17
    v_mul_f32 v16, 0x37800000, v16
    v_cvt_pk_bf16_f32 v16, v16, v16
    v_lshlrev_b32 v16, 16, v16
    ds_write_b32 v6, v16 offset:24576
    s_waitcnt lgkmcnt(0)
L_b4:
    s_barrier
    v_and_b32 v6, 63, v0
    v_lshlrev_b32 v6, 2, v6
    ds_read_b32 v16, v6 offset:24576
    ds_read_b32 v17, v6 offset:24832
    ds_read_b32 v18, v6 offset:25088
    ds_read_b32 v19, v6 offset:25344
    ds_read_b32 v20, v6 offset:25600
    ds_read_b32 v21, v6 offset:25856
    s_waitcnt lgkmcnt(0)
    v_mul_f32 v8, v16, v96
    v_mul_f32 v9, v16, v97
    v_fmac_f32 v8, v17, v98
    v_fmac_f32 v9, v17, v99
    v_fmac_f32 v8, v18, v100
    v_fmac_f32 v9, v18, v101
    v_fmac_f32 v8, v19, v102
    v_fmac_f32 v9, v19, v103
    v_fmac_f32 v8, v20, v104
    v_fmac_f32 v9, v20, v105
    v_fmac_f32 v8, v21, v106
    v_fmac_f32 v9, v21, v107
    s_nop 1
    v_add_f32_dpp v8, v8, v8 row_shr:1 row_mask:0xf bank_mask:0xf bound_ctrl:0
    v_add_f32_dpp v9, v9, v9 row_shr:1 row_mask:0xf bank_mask:0xf bound_ctrl:0
    s_nop 0
    v_add_f32_dpp v8, v8, v8 row_shr:2 row_mask:0xf bank_mask:0xf bound_ctrl:0
    v_add_f32_dpp v9, v9, v9 row_shr:2 row_mask:0xf bank_mask:0xf bound_ctrl:0
    s_nop 0
    v_add_f32_dpp v8, v8, v8 row_shr:4 row_mask:0xf bank_mask:0xf bound_ctrl:0
    v_add_f32_dpp v9, v9, v9 row_shr:4 row_mask:0xf bank_mask:0xf bound_ctrl:0
    s_nop 0
    v_add_f32_dpp v8, v8, v8 row_shr:8 row_mask:0xf bank_mask:0xf bound_ctrl:0
    v_add_f32_dpp v9, v9, v9 row_shr:8 row_mask:0xf bank_mask:0xf bound_ctrl:0
    s_nop 0
    v_add_f32_dpp v8, v8, v8 row_bcast:15 row_mask:0xa bank_mask:0xf
    v_add_f32_dpp v9, v9, v9 row_bcast:15 row_mask:0xa bank_mask:0xf
    s_nop 0
    v_add_f32_dpp v8, v8, v8 row_bcast:31 row_mask:0xc bank_mask:0xf
    v_add_f32_dpp v9, v9, v9 row_bcast:31 row_mask:0xc bank_mask:0xf
    v_cvt_pk_bf16_f32 v10, v8, v9
    v_lshlrev_b32 v8, 16, v10
    v_and_b32 v9, 0xffff0000, v10
    v_mul_f32 v10, 0xbfb8aa3b, v8
    v_mul_f32 v11, 0xbfb8aa3b, v9
    v_exp_f32 v10, v10
    v_exp_f32 v11, v11
    v_add_f32 v10, 1.0, v10
    v_add_f32 v11, 1.0, v11
    v_rcp_f32 v10, v10
    v_rcp_f32 v11, v11
    v_mul_f32 v8, v8, v10
    v_mul_f32 v9, v9, v11
    v_cvt_pk_bf16_f32 v10, v8, v9
    v_lshlrev_b32 v8, 16, v10
    v_and_b32 v9, 0xffff0000, v10
    s_lshl_b32 s33, s31, 3
    v_mov_b32 v10, s33
    v_and_b32 v11, 63, v0
    v_cmp_eq_u32 vcc, 63, v11
    s_and_saveexec_b64 s[34:35], vcc
    ds_write_b64 v10, v[8:9] offset:26112
    s_mov_b64 exec, s[34:35]
    s_waitcnt lgkmcnt(0)
    s_barrier
    s_cmp_ge_u32 s31, 6
    s_cbranch_scc1 L_b6
    v_mov_b32 v6, 0
    ds_read_b128 v[16:19], v6 offset:26112
    ds_read_b128 v[20:23], v6 offset:26128
    ds_read_b128 v[24:27], v6 offset:26144
    ds_read_b128 v[28:31], v6 offset:26160
    ds_read_b128 v[96:99], v6 offset:26176
    ds_read_b128 v[100:103], v6 offset:26192
    s_waitcnt lgkmcnt(0)
    v_mul_f32 v7, v16, v108
    v_mul_f32 v8, v17, v109
    v_fmac_f32 v7, v18, v110
    v_fmac_f32 v8, v19, v111
    v_fmac_f32 v7, v20, v112
    v_fmac_f32 v8, v21, v113
    v_fmac_f32 v7, v22, v114
    v_fmac_f32 v8, v23, v115
    v_fmac_f32 v7, v24, v116
    v_fmac_f32 v8, v25, v117
    v_fmac_f32 v7, v26, v118
    v_fmac_f32 v8, v27, v119
    v_fmac_f32 v7, v28, v120
    v_fmac_f32 v8, v29, v121
    v_fmac_f32 v7, v30, v122
    v_fmac_f32 v8, v31, v123
    v_fmac_f32 v7, v96, v124
    v_fmac_f32 v8, v97, v125
    v_fmac_f32 v7, v98, v126
    v_fmac_f32 v8, v99, v127
    v_fmac_f32 v7, v100, v128
    v_fmac_f32 v8, v101, v129
    v_fmac_f32 v7, v102, v130
    v_fmac_f32 v8, v103, v131
    v_add_f32 v7, v7, v8
    v_cvt_pk_bf16_f32 v7, v7, v7
    v_lshlrev_b32 v7, 16, v7
    v_mul_f32 v7, 0xbfb8aa3b, v7
    v_exp_f32 v7, v7
    s_nop 0
    v_add_f32 v7, 1.0, v7
    v_rcp_f32 v7, v7
    s_nop 0
    v_cvt_pk_bf16_f32 v7, v7, v7
    v_lshlrev_b32 v7, 16, v7
    v_lshlrev_b32 v8, 2, v0
    ds_write_b32 v8, v7 offset:26240
    s_waitcnt lgkmcnt(0)
L_b6:
    s_barrier
    v_lshlrev_b32 v6, 5, v3
    ds_read_b128 v[24:27], v6 offset:26240
    ds_read_b128 v[28:31], v6 offset:26256
    s_waitcnt lgkmcnt(0)
    v_lshlrev_b32 v6, 16, v32
    v_and_b32 v7, 0xffff0000, v32
    v_pk_mul_f32 v[6:7], v[6:7], v[24:25]
    v_cvt_pk_bf16_f32 v32, v6, v7
    v_lshlrev_b32 v8, 16, v33
    v_and_b32 v9, 0xffff0000, v33
    v_pk_mul_f32 v[8:9], v[8:9], v[26:27]
    v_cvt_pk_bf16_f32 v33, v8, v9
    v_lshlrev_b32 v6, 16, v34
    v_and_b32 v7, 0xffff0000, v34
    v_pk_mul_f32 v[6:7], v[6:7], v[28:29]
    v_cvt_pk_bf16_f32 v34, v6, v7
    v_lshlrev_b32 v8, 16, v35
    v_and_b32 v9, 0xffff0000, v35
    v_pk_mul_f32 v[8:9], v[8:9], v[30:31]
    v_cvt_pk_bf16_f32 v35, v8, v9
    buffer_store_dwordx4 v[32:35], v1, s[8:11], s48 offen
    v_lshlrev_b32 v6, 16, v36
    v_and_b32 v7, 0xffff0000, v36
    v_pk_mul_f32 v[6:7], v[6:7], v[24:25]
    v_cvt_pk_bf16_f32 v36, v6, v7
    v_lshlrev_b32 v8, 16, v37
    v_and_b32 v9, 0xffff0000, v37
    v_pk_mul_f32 v[8:9], v[8:9], v[26:27]
    v_cvt_pk_bf16_f32 v37, v8, v9
    v_lshlrev_b32 v6, 16, v38
    v_and_b32 v7, 0xffff0000, v38
    v_pk_mul_f32 v[6:7], v[6:7], v[28:29]
    v_cvt_pk_bf16_f32 v38, v6, v7
    v_lshlrev_b32 v8, 16, v39
    v_and_b32 v9, 0xffff0000, v39
    v_pk_mul_f32 v[8:9], v[8:9], v[30:31]
    v_cvt_pk_bf16_f32 v39, v8, v9
    buffer_store_dwordx4 v[36:39], v1, s[8:11], s49 offen
    v_lshlrev_b32 v6, 16, v40
    v_and_b32 v7, 0xffff0000, v40
    v_pk_mul_f32 v[6:7], v[6:7], v[24:25]
    v_cvt_pk_bf16_f32 v40, v6, v7
    v_lshlrev_b32 v8, 16, v41
    v_and_b32 v9, 0xffff0000, v41
    v_pk_mul_f32 v[8:9], v[8:9], v[26:27]
    v_cvt_pk_bf16_f32 v41, v8, v9
    v_lshlrev_b32 v6, 16, v42
    v_and_b32 v7, 0xffff0000, v42
    v_pk_mul_f32 v[6:7], v[6:7], v[28:29]
    v_cvt_pk_bf16_f32 v42, v6, v7
    v_lshlrev_b32 v8, 16, v43
    v_and_b32 v9, 0xffff0000, v43
    v_pk_mul_f32 v[8:9], v[8:9], v[30:31]
    v_cvt_pk_bf16_f32 v43, v8, v9
    buffer_store_dwordx4 v[40:43], v1, s[8:11], s50 offen
    v_lshlrev_b32 v6, 16, v44
    v_and_b32 v7, 0xffff0000, v44
    v_pk_mul_f32 v[6:7], v[6:7], v[24:25]
    v_cvt_pk_bf16_f32 v44, v6, v7
    v_lshlrev_b32 v8, 16, v45
    v_and_b32 v9, 0xffff0000, v45
    v_pk_mul_f32 v[8:9], v[8:9], v[26:27]
    v_cvt_pk_bf16_f32 v45, v8, v9
    v_lshlrev_b32 v6, 16, v46
    v_and_b32 v7, 0xffff0000, v46
    v_pk_mul_f32 v[6:7], v[6:7], v[28:29]
    v_cvt_pk_bf16_f32 v46, v6, v7
    v_lshlrev_b32 v8, 16, v47
    v_and_b32 v9, 0xffff0000, v47
    v_pk_mul_f32 v[8:9], v[8:9], v[30:31]
    v_cvt_pk_bf16_f32 v47, v8, v9
    buffer_store_dwordx4 v[44:47], v1, s[8:11], s51 offen
    v_lshlrev_b32 v6, 16, v48
    v_and_b32 v7, 0xffff0000, v48
    v_pk_mul_f32 v[6:7], v[6:7], v[24:25]
    v_cvt_pk_bf16_f32 v48, v6, v7
    v_lshlrev_b32 v8, 16, v49
    v_and_b32 v9, 0xffff0000, v49
    v_pk_mul_f32 v[8:9], v[8:9], v[26:27]
    v_cvt_pk_bf16_f32 v49, v8, v9
    v_lshlrev_b32 v6, 16, v50
    v_and_b32 v7, 0xffff0000, v50
    v_pk_mul_f32 v[6:7], v[6:7], v[28:29]
    v_cvt_pk_bf16_f32 v50, v6, v7
    v_lshlrev_b32 v8, 16, v51
    v_and_b32 v9, 0xffff0000, v51
    v_pk_mul_f32 v[8:9], v[8:9], v[30:31]
    v_cvt_pk_bf16_f32 v51, v8, v9
    buffer_store_dwordx4 v[48:51], v1, s[8:11], s52 offen
    v_lshlrev_b32 v6, 16, v52
    v_and_b32 v7, 0xffff0000, v52
    v_pk_mul_f32 v[6:7], v[6:7], v[24:25]
    v_cvt_pk_bf16_f32 v52, v6, v7
    v_lshlrev_b32 v8, 16, v53
    v_and_b32 v9, 0xffff0000, v53
    v_pk_mul_f32 v[8:9], v[8:9], v[26:27]
    v_cvt_pk_bf16_f32 v53, v8, v9
    v_lshlrev_b32 v6, 16, v54
    v_and_b32 v7, 0xffff0000, v54
    v_pk_mul_f32 v[6:7], v[6:7], v[28:29]
    v_cvt_pk_bf16_f32 v54, v6, v7
    v_lshlrev_b32 v8, 16, v55
    v_and_b32 v9, 0xffff0000, v55
    v_pk_mul_f32 v[8:9], v[8:9], v[30:31]
    v_cvt_pk_bf16_f32 v55, v8, v9
    buffer_store_dwordx4 v[52:55], v1, s[8:11], s53 offen
    v_lshlrev_b32 v6, 16, v56
    v_and_b32 v7, 0xffff0000, v56
    v_pk_mul_f32 v[6:7], v[6:7], v[24:25]
    v_cvt_pk_bf16_f32 v56, v6, v7
    v_lshlrev_b32 v8, 16, v57
    v_and_b32 v9, 0xffff0000, v57
    v_pk_mul_f32 v[8:9], v[8:9], v[26:27]
    v_cvt_pk_bf16_f32 v57, v8, v9
    v_lshlrev_b32 v6, 16, v58
    v_and_b32 v7, 0xffff0000, v58
    v_pk_mul_f32 v[6:7], v[6:7], v[28:29]
    v_cvt_pk_bf16_f32 v58, v6, v7
    v_lshlrev_b32 v8, 16, v59
    v_and_b32 v9, 0xffff0000, v59
    v_pk_mul_f32 v[8:9], v[8:9], v[30:31]
    v_cvt_pk_bf16_f32 v59, v8, v9
    buffer_store_dwordx4 v[56:59], v1, s[8:11], s54 offen
    v_lshlrev_b32 v6, 16, v60
    v_and_b32 v7, 0xffff0000, v60
    v_pk_mul_f32 v[6:7], v[6:7], v[24:25]
    v_cvt_pk_bf16_f32 v60, v6, v7
    v_lshlrev_b32 v8, 16, v61
    v_and_b32 v9, 0xffff0000, v61
    v_pk_mul_f32 v[8:9], v[8:9], v[26:27]
    v_cvt_pk_bf16_f32 v61, v8, v9
    v_lshlrev_b32 v6, 16, v62
    v_and_b32 v7, 0xffff0000, v62
    v_pk_mul_f32 v[6:7], v[6:7], v[28:29]
    v_cvt_pk_bf16_f32 v62, v6, v7
    v_lshlrev_b32 v8, 16, v63
    v_and_b32 v9, 0xffff0000, v63
    v_pk_mul_f32 v[8:9], v[8:9], v[30:31]
    v_cvt_pk_bf16_f32 v63, v8, v9
    buffer_store_dwordx4 v[60:63], v1, s[8:11], s55 offen
    v_lshlrev_b32 v6, 16, v64
    v_and_b32 v7, 0xffff0000, v64
    v_pk_mul_f32 v[6:7], v[6:7], v[24:25]
    v_cvt_pk_bf16_f32 v64, v6, v7
    v_lshlrev_b32 v8, 16, v65
    v_and_b32 v9, 0xffff0000, v65
    v_pk_mul_f32 v[8:9], v[8:9], v[26:27]
    v_cvt_pk_bf16_f32 v65, v8, v9
    v_lshlrev_b32 v6, 16, v66
    v_and_b32 v7, 0xffff0000, v66
    v_pk_mul_f32 v[6:7], v[6:7], v[28:29]
    v_cvt_pk_bf16_f32 v66, v6, v7
    v_lshlrev_b32 v8, 16, v67
    v_and_b32 v9, 0xffff0000, v67
    v_pk_mul_f32 v[8:9], v[8:9], v[30:31]
    v_cvt_pk_bf16_f32 v67, v8, v9
    buffer_store_dwordx4 v[64:67], v1, s[8:11], s56 offen
    v_lshlrev_b32 v6, 16, v68
    v_and_b32 v7, 0xffff0000, v68
    v_pk_mul_f32 v[6:7], v[6:7], v[24:25]
    v_cvt_pk_bf16_f32 v68, v6, v7
    v_lshlrev_b32 v8, 16, v69
    v_and_b32 v9, 0xffff0000, v69
    v_pk_mul_f32 v[8:9], v[8:9], v[26:27]
    v_cvt_pk_bf16_f32 v69, v8, v9
    v_lshlrev_b32 v6, 16, v70
    v_and_b32 v7, 0xffff0000, v70
    v_pk_mul_f32 v[6:7], v[6:7], v[28:29]
    v_cvt_pk_bf16_f32 v70, v6, v7
    v_lshlrev_b32 v8, 16, v71
    v_and_b32 v9, 0xffff0000, v71
    v_pk_mul_f32 v[8:9], v[8:9], v[30:31]
    v_cvt_pk_bf16_f32 v71, v8, v9
    buffer_store_dwordx4 v[68:71], v1, s[8:11], s57 offen
    v_lshlrev_b32 v6, 16, v72
    v_and_b32 v7, 0xffff0000, v72
    v_pk_mul_f32 v[6:7], v[6:7], v[24:25]
    v_cvt_pk_bf16_f32 v72, v6, v7
    v_lshlrev_b32 v8, 16, v73
    v_and_b32 v9, 0xffff0000, v73
    v_pk_mul_f32 v[8:9], v[8:9], v[26:27]
    v_cvt_pk_bf16_f32 v73, v8, v9
    v_lshlrev_b32 v6, 16, v74
    v_and_b32 v7, 0xffff0000, v74
    v_pk_mul_f32 v[6:7], v[6:7], v[28:29]
    v_cvt_pk_bf16_f32 v74, v6, v7
    v_lshlrev_b32 v8, 16, v75
    v_and_b32 v9, 0xffff0000, v75
    v_pk_mul_f32 v[8:9], v[8:9], v[30:31]
    v_cvt_pk_bf16_f32 v75, v8, v9
    buffer_store_dwordx4 v[72:75], v1, s[8:11], s58 offen
    v_lshlrev_b32 v6, 16, v76
    v_and_b32 v7, 0xffff0000, v76
    v_pk_mul_f32 v[6:7], v[6:7], v[24:25]
    v_cvt_pk_bf16_f32 v76, v6, v7
    v_lshlrev_b32 v8, 16, v77
    v_and_b32 v9, 0xffff0000, v77
    v_pk_mul_f32 v[8:9], v[8:9], v[26:27]
    v_cvt_pk_bf16_f32 v77, v8, v9
    v_lshlrev_b32 v6, 16, v78
    v_and_b32 v7, 0xffff0000, v78
    v_pk_mul_f32 v[6:7], v[6:7], v[28:29]
    v_cvt_pk_bf16_f32 v78, v6, v7
    v_lshlrev_b32 v8, 16, v79
    v_and_b32 v9, 0xffff0000, v79
    v_pk_mul_f32 v[8:9], v[8:9], v[30:31]
    v_cvt_pk_bf16_f32 v79, v8, v9
    buffer_store_dwordx4 v[76:79], v1, s[8:11], s59 offen
    v_lshlrev_b32 v6, 16, v80
    v_and_b32 v7, 0xffff0000, v80
    v_pk_mul_f32 v[6:7], v[6:7], v[24:25]
    v_cvt_pk_bf16_f32 v80, v6, v7
    v_lshlrev_b32 v8, 16, v81
    v_and_b32 v9, 0xffff0000, v81
    v_pk_mul_f32 v[8:9], v[8:9], v[26:27]
    v_cvt_pk_bf16_f32 v81, v8, v9
    v_lshlrev_b32 v6, 16, v82
    v_and_b32 v7, 0xffff0000, v82
    v_pk_mul_f32 v[6:7], v[6:7], v[28:29]
    v_cvt_pk_bf16_f32 v82, v6, v7
    v_lshlrev_b32 v8, 16, v83
    v_and_b32 v9, 0xffff0000, v83
    v_pk_mul_f32 v[8:9], v[8:9], v[30:31]
    v_cvt_pk_bf16_f32 v83, v8, v9
    buffer_store_dwordx4 v[80:83], v1, s[8:11], s60 offen
    v_lshlrev_b32 v6, 16, v84
    v_and_b32 v7, 0xffff0000, v84
    v_pk_mul_f32 v[6:7], v[6:7], v[24:25]
    v_cvt_pk_bf16_f32 v84, v6, v7
    v_lshlrev_b32 v8, 16, v85
    v_and_b32 v9, 0xffff0000, v85
    v_pk_mul_f32 v[8:9], v[8:9], v[26:27]
    v_cvt_pk_bf16_f32 v85, v8, v9
    v_lshlrev_b32 v6, 16, v86
    v_and_b32 v7, 0xffff0000, v86
    v_pk_mul_f32 v[6:7], v[6:7], v[28:29]
    v_cvt_pk_bf16_f32 v86, v6, v7
    v_lshlrev_b32 v8, 16, v87
    v_and_b32 v9, 0xffff0000, v87
    v_pk_mul_f32 v[8:9], v[8:9], v[30:31]
    v_cvt_pk_bf16_f32 v87, v8, v9
    buffer_store_dwordx4 v[84:87], v1, s[8:11], s61 offen
    v_lshlrev_b32 v6, 16, v88
    v_and_b32 v7, 0xffff0000, v88
    v_pk_mul_f32 v[6:7], v[6:7], v[24:25]
    v_cvt_pk_bf16_f32 v88, v6, v7
    v_lshlrev_b32 v8, 16, v89
    v_and_b32 v9, 0xffff0000, v89
    v_pk_mul_f32 v[8:9], v[8:9], v[26:27]
    v_cvt_pk_bf16_f32 v89, v8, v9
    v_lshlrev_b32 v6, 16, v90
    v_and_b32 v7, 0xffff0000, v90
    v_pk_mul_f32 v[6:7], v[6:7], v[28:29]
    v_cvt_pk_bf16_f32 v90, v6, v7
    v_lshlrev_b32 v8, 16, v91
    v_and_b32 v9, 0xffff0000, v91
    v_pk_mul_f32 v[8:9], v[8:9], v[30:31]
    v_cvt_pk_bf16_f32 v91, v8, v9
    buffer_store_dwordx4 v[88:91], v1, s[8:11], s62 offen
    v_lshlrev_b32 v6, 16, v92
    v_and_b32 v7, 0xffff0000, v92
    v_pk_mul_f32 v[6:7], v[6:7], v[24:25]
    v_cvt_pk_bf16_f32 v92, v6, v7
    v_lshlrev_b32 v8, 16, v93
    v_and_b32 v9, 0xffff0000, v93
    v_pk_mul_f32 v[8:9], v[8:9], v[26:27]
    v_cvt_pk_bf16_f32 v93, v8, v9
    v_lshlrev_b32 v6, 16, v94
    v_and_b32 v7, 0xffff0000, v94
    v_pk_mul_f32 v[6:7], v[6:7], v[28:29]
    v_cvt_pk_bf16_f32 v94, v6, v7
    v_lshlrev_b32 v8, 16, v95
    v_and_b32 v9, 0xffff0000, v95
    v_pk_mul_f32 v[8:9], v[8:9], v[30:31]
    v_cvt_pk_bf16_f32 v95, v8, v9
    buffer_store_dwordx4 v[92:95], v1, s[8:11], s63 offen
L_end:
    s_endpgm
.section .rodata,"a"
.p2align 6
.amdhsa_kernel standalone__channel_attn_se__vision_kernel
  .amdhsa_next_free_vgpr 136
  .amdhsa_next_free_sgpr 96
  .amdhsa_accum_offset 136
  .amdhsa_group_segment_fixed_size 0
  .amdhsa_kernarg_size 48
  .amdhsa_user_sgpr_count 2
  .amdhsa_user_sgpr_kernarg_segment_ptr 1
  .amdhsa_system_sgpr_workgroup_id_x 1
  .amdhsa_float_denorm_mode_32 3
.end_amdhsa_kernel
```
